```python
import torch

def _softmax(x, axis=-1):
    return torch.softmax(x, dim=axis)
def _gelu(x):
    return torch.nn.functional.gelu(x, approximate="tanh")
def _silu(x):
    return torch.nn.functional.silu(x)
def _sigmoid(x):
    return torch.sigmoid(x)
def _layernorm(x, axis=-1, eps=1e-5):
    m = x.mean(dim=axis, keepdim=True)
    v = x.var(dim=axis, keepdim=True, unbiased=False)
    return (x - m) / torch.sqrt(v + eps)
def _scatter_add(tgt, idx, src, axis=0):
    return tgt.clone().index_add_(axis, idx, src)
def _segment_sum(src, seg, n):
    out = torch.zeros((n,) + src.shape[1:], dtype=src.dtype)
    return out.index_add_(0, seg, src)
def _pad(x, pw):
    flat = tuple(v for pair in reversed(pw) for v in pair)
    return torch.nn.functional.pad(x, flat)

kernel_name = 'standalone__gqa_softmax__near_ridge'

def setup_inputs():

    _w = (lambda a: (lambda t: t.to(torch.bfloat16) if t.is_floating_point() else t)(torch.as_tensor(a)))
    B, Hq, Hkv, Sq, Sk, D = 8, 16, 8, 128, 2048, 256
    return {
        "q": _w((lambda *s: torch.randn(*s, dtype=torch.bfloat16) * 0.8)(B, Hq, Sq, D)),
        "k": _w((lambda *s: torch.randn(*s, dtype=torch.bfloat16) * 0.8)(B, Hkv, Sk, D)),
        "v": _w((lambda *s: torch.randn(*s, dtype=torch.bfloat16) * 0.05)(B, Hkv, Sk, D)),
    }

def reference(q, k, v):
    B, Hq, Sq, D = q.shape
    Hkv = k.shape[1]
    rep = Hq // Hkv
    k = (lambda x, n, axis: torch.repeat_interleave(x, n, dim=axis))(k, rep, axis=1)
    v = (lambda x, n, axis: torch.repeat_interleave(x, n, dim=axis))(v, rep, axis=1)
    scale = D ** -0.5
    scores = torch.einsum("bhqd,bhkd->bhqk", q, k) * scale
    p = _softmax(scores, axis=-1)
    return torch.einsum("bhqk,bhkd->bhqd", p, v)
```

```asm
; @launch grid=(256,1,1) block=(256,1,1) lds=163840
.amdgcn_target "amdgcn-amd-amdhsa--gfx950"
.text
.globl standalone__gqa_softmax__near_ridge_kernel
.p2align 8
.type standalone__gqa_softmax__near_ridge_kernel,@function
standalone__gqa_softmax__near_ridge_kernel:
s_load_dwordx8 s[4:11], s[0:1], 0
s_load_dwordx4 s[12:15], s[0:1], 32
s_getpc_b64 s[32:33]
s_lshr_b32 s42, s2, 3
v_and_b32 v16, 7, v0
v_mad_u32_u24 v16, s42, 5, v16
v_lshlrev_b32 v16, 7, v16
v_mov_b32 v17, s33
v_add_co_u32 v16, vcc, s32, v16
s_nop 1
v_addc_co_u32 v17, vcc, 0, v17, vcc
global_load_dword v222, v[16:17], off
s_cmp_ge_u32 s2, 256
s_cbranch_scc1 L_end
v_lshrrev_b32 v16, 6, v0
v_and_b32 v0, 63, v0
v_readfirstlane_b32 s40, v16
s_and_b32 s41, s2, 7
s_lshl_b32 s41, s41, 5
s_lshr_b32 s42, s2, 3
s_add_u32 s41, s41, s42
s_lshr_b32 s42, s41, 2
s_bfe_u32 s44, s41, 0x10001
v_lshrrev_b32 v17, 4, v0
v_bfe_u32 v18, v0, 3, 1
v_lshlrev_b32 v18, 9, v18
v_lshl_add_u32 v18, v17, 12, v18
v_and_b32 v19, 7, v0
v_xor_b32 v20, v19, v17
v_lshl_add_u32 v1, v20, 4, v18
v_xor_b32 v2, 64, v1
s_lshl_b32 s53, s42, 20
s_lshl_b32 s52, s44, 19
s_add_u32 s53, s53, s52
s_mov_b32 s18, 0x80000
s_mov_b32 s19, 0x20000
s_lshl_b32 s45, s40, 7
s_lshl_b32 s48, s40, 12
s_add_u32 s48, s48, 114688
s_add_u32 m0, s48, 16384
s_and_b32 s43, s41, 1
s_lshl_b32 s52, s42, 1
s_add_u32 s52, s52, s43
s_lshl_b32 s52, s52, 16
s_mov_b32 s26, 0x10000
s_mov_b32 s27, 0x20000
s_lshl_b32 s49, s40, 14
s_add_u32 s68, s49, 49152
s_waitcnt lgkmcnt(0)
s_add_u32 s16, s6, s53
s_addc_u32 s17, s7, 0
buffer_load_dwordx4 v1, s[16:19], s45 offen offset:0 nt lds
buffer_load_dwordx4 v2, s[16:19], s45 offen offset:1024 nt lds
buffer_load_dwordx4 v1, s[16:19], s45 offen offset:2048 nt lds
buffer_load_dwordx4 v2, s[16:19], s45 offen offset:3072 nt lds
s_add_u32 s24, s4, s52
s_addc_u32 s25, s5, 0
s_xor_b32 s46, s44, 1
s_lshl_b32 s46, s46, 8
s_xor_b32 s46, s46, s45
s_add_u32 m0, s68, 0
s_add_u32 s45, s45, 0x4000
buffer_load_dwordx4 v1, s[24:27], s49 offen offset:0 nt lds
buffer_load_dwordx4 v2, s[24:27], s49 offen offset:1024 nt lds
buffer_load_dwordx4 v1, s[24:27], s49 offen offset:2048 nt lds
buffer_load_dwordx4 v2, s[24:27], s49 offen offset:3072 nt lds
s_add_u32 m0, s68, 4096
s_add_u32 s49, s49, 128
buffer_load_dwordx4 v1, s[24:27], s49 offen offset:0 nt lds
buffer_load_dwordx4 v2, s[24:27], s49 offen offset:1024 nt lds
buffer_load_dwordx4 v1, s[24:27], s49 offen offset:2048 nt lds
buffer_load_dwordx4 v2, s[24:27], s49 offen offset:3072 nt lds
s_add_u32 m0, s68, 8192
s_add_u32 s49, s49, 128
buffer_load_dwordx4 v1, s[24:27], s49 offen offset:0 nt lds
buffer_load_dwordx4 v2, s[24:27], s49 offen offset:1024 nt lds
buffer_load_dwordx4 v1, s[24:27], s49 offen offset:2048 nt lds
buffer_load_dwordx4 v2, s[24:27], s49 offen offset:3072 nt lds
s_add_u32 m0, s68, 12288
s_add_u32 s49, s49, 128
buffer_load_dwordx4 v1, s[24:27], s49 offen offset:0 nt lds
buffer_load_dwordx4 v2, s[24:27], s49 offen offset:1024 nt lds
buffer_load_dwordx4 v1, s[24:27], s49 offen offset:2048 nt lds
buffer_load_dwordx4 v2, s[24:27], s49 offen offset:3072 nt lds
v_lshlrev_b32 v20, 1, v17
v_xor_b32 v20, v19, v20
v_lshl_add_u32 v3, v20, 4, v18
v_lshlrev_b32 v144, 7, v0
s_mov_b32 s22, 0x80000
s_mov_b32 s23, 0x20000
s_mov_b32 s58, 512
s_mov_b32 s59, 0x20000
s_lshl_b32 s54, s42, 9
s_add_u32 s54, s54, 65536
s_add_u32 s56, s14, s54
s_addc_u32 s57, s15, 0
s_cmp_lg_u32 s40, 0
s_cbranch_scc1 L_noflag0
buffer_load_dword v144, v144, s[56:59], 0 offen sc1
L_noflag0:
s_add_u32 s20, s8, s53
s_addc_u32 s21, s9, 0
s_add_u32 s28, s10, s52
s_addc_u32 s29, s11, 0
s_mov_b32 s30, 0x10000
s_mov_b32 s31, 0x20000
s_mul_i32 s67, s40, 9216
s_add_u32 s67, s67, 1048576
s_mul_i32 s53, s41, 36864
s_add_u32 s53, s53, s67
s_add_u32 s32, s14, s53
s_addc_u32 s33, s15, 0
s_mov_b32 s34, 9216
s_mov_b32 s35, 0x20000
s_xor_b32 s53, s41, 2
s_mul_i32 s53, s53, 36864
s_add_u32 s53, s53, s67
s_add_u32 s36, s14, s53
s_addc_u32 s37, s15, 0
s_mov_b32 s38, 9216
s_mov_b32 s39, 0x20000
s_mov_b32 s50, 0x3db8aa3b
s_mov_b32 s51, 0x4b800000
s_lshl_b32 s61, s40, 12
s_add_u32 s53, s61, 16384
s_cmp_lt_u32 s40, 2
s_cselect_b32 s61, s61, s53
s_mov_b32 s62, 0x6000
s_cselect_b32 s64, 0, 0x28000
s_mov_b32 s60, s61
s_add_u32 s61, s61, 0x6000
s_mov_b32 s47, 0
s_mov_b32 s66, 8
s_lshl_b32 s3, s40, 11
s_lshr_b32 s53, s40, 1
s_lshl_b32 s53, s53, 7
s_xor_b32 s67, s44, 1
s_lshl_b32 s67, s67, 8
s_xor_b32 s53, s53, s67
s_and_b32 s67, s3, 2048
s_add_u32 s53, s53, s67
s_add_u32 s101, s53, 442368
s_xor_b32 s65, s101, 256
s_add_u32 s100, s3, 49152
s_sub_u32 s65, s65, 49152
v_and_b32 v21, 15, v0
v_lshrrev_b32 v16, 1, v21
v_xor_b32 v16, v16, v17
v_lshlrev_b32 v16, 4, v16
v_lshl_add_u32 v16, v21, 7, v16
v_add_u32 v4, 131072, v16
v_add_u32 v148, s68, v16
v_xor_b32 v5, 64, v4
v_xor_b32 v149, 64, v148
v_lshrrev_b32 v16, 2, v0
v_bfe_u32 v18, v0, 3, 2
v_lshlrev_b32 v18, 1, v18
v_bfe_u32 v19, v0, 1, 1
v_xor_b32 v18, v18, v19
v_lshlrev_b32 v18, 4, v18
v_lshl_add_u32 v18, v16, 7, v18
v_and_b32 v19, 1, v0
v_lshl_add_u32 v18, v19, 3, v18
v_add_u32 v6, 0, v18
v_xor_b32 v7, 32, v6
v_xor_b32 v8, 64, v6
v_xor_b32 v9, 96, v6
v_mov_b32 v48, 0
v_mov_b32 v49, 0
v_mov_b32 v50, 0
v_mov_b32 v51, 0
s_nop 1
v_mfma_f32_32x32x16_bf16 a[0:15], v[48:51], v[48:51], 0
v_mfma_f32_32x32x16_bf16 a[16:31], v[48:51], v[48:51], 0
v_mfma_f32_32x32x16_bf16 a[32:47], v[48:51], v[48:51], 0
v_mfma_f32_32x32x16_bf16 a[48:63], v[48:51], v[48:51], 0
v_mfma_f32_32x32x16_bf16 a[64:79], v[48:51], v[48:51], 0
v_mfma_f32_32x32x16_bf16 a[80:95], v[48:51], v[48:51], 0
v_mfma_f32_32x32x16_bf16 a[96:111], v[48:51], v[48:51], 0
v_mfma_f32_32x32x16_bf16 a[112:127], v[48:51], v[48:51], 0
v_mov_b32 v14, 0
v_mov_b32 v15, 0
s_waitcnt vmcnt(12)
s_barrier
ds_read_b128 a[192:195], v4 offset:0
ds_read_b128 v[80:83], v148 offset:0
ds_read_b128 a[196:199], v4 offset:2048
ds_read_b128 v[112:115], v148 offset:2048
ds_read_b128 a[200:203], v5 offset:0
ds_read_b128 v[84:87], v149 offset:0
ds_read_b128 a[204:207], v5 offset:2048
ds_read_b128 v[116:119], v149 offset:2048
s_waitcnt vmcnt(8)
ds_read_b128 a[208:211], v4 offset:4096
ds_read_b128 v[88:91], v148 offset:4096
ds_read_b128 a[212:215], v4 offset:6144
ds_read_b128 v[120:123], v148 offset:6144
ds_read_b128 a[216:219], v5 offset:4096
ds_read_b128 v[92:95], v149 offset:4096
ds_read_b128 a[220:223], v5 offset:6144
ds_read_b128 v[124:127], v149 offset:6144
s_add_u32 m0, s48, 32768
s_nop 0
buffer_load_dwordx4 v1, s[16:19], s45 offen offset:0 nt lds
buffer_load_dwordx4 v2, s[16:19], s45 offen offset:1024 nt lds
buffer_load_dwordx4 v1, s[16:19], s45 offen offset:2048 nt lds
buffer_load_dwordx4 v2, s[16:19], s45 offen offset:3072 nt lds
s_add_u32 s45, s45, 0x4000
s_waitcnt lgkmcnt(8)
v_lshlrev_b32 v16, 16, v80
v_and_b32 v17, 0xffff0000, v80
v_pk_mul_f32 v[16:17], v[16:17], s[50:51] op_sel_hi:[1,0]
v_cvt_pk_bf16_f32 v80, v16, v17
v_lshlrev_b32 v18, 16, v81
v_and_b32 v19, 0xffff0000, v81
v_pk_mul_f32 v[18:19], v[18:19], s[50:51] op_sel_hi:[1,0]
v_cvt_pk_bf16_f32 v81, v18, v19
v_lshlrev_b32 v20, 16, v82
v_and_b32 v21, 0xffff0000, v82
v_pk_mul_f32 v[20:21], v[20:21], s[50:51] op_sel_hi:[1,0]
v_cvt_pk_bf16_f32 v82, v20, v21
v_lshlrev_b32 v22, 16, v83
v_and_b32 v23, 0xffff0000, v83
v_pk_mul_f32 v[22:23], v[22:23], s[50:51] op_sel_hi:[1,0]
v_cvt_pk_bf16_f32 v83, v22, v23
v_lshlrev_b32 v16, 16, v112
v_and_b32 v17, 0xffff0000, v112
v_pk_mul_f32 v[16:17], v[16:17], s[50:51] op_sel_hi:[1,0]
v_cvt_pk_bf16_f32 v112, v16, v17
v_lshlrev_b32 v18, 16, v113
v_and_b32 v19, 0xffff0000, v113
v_pk_mul_f32 v[18:19], v[18:19], s[50:51] op_sel_hi:[1,0]
v_cvt_pk_bf16_f32 v113, v18, v19
v_lshlrev_b32 v20, 16, v114
v_and_b32 v21, 0xffff0000, v114
v_pk_mul_f32 v[20:21], v[20:21], s[50:51] op_sel_hi:[1,0]
v_cvt_pk_bf16_f32 v114, v20, v21
v_lshlrev_b32 v22, 16, v115
v_and_b32 v23, 0xffff0000, v115
v_pk_mul_f32 v[22:23], v[22:23], s[50:51] op_sel_hi:[1,0]
v_cvt_pk_bf16_f32 v115, v22, v23
v_lshlrev_b32 v16, 16, v84
v_and_b32 v17, 0xffff0000, v84
v_pk_mul_f32 v[16:17], v[16:17], s[50:51] op_sel_hi:[1,0]
v_cvt_pk_bf16_f32 v84, v16, v17
v_lshlrev_b32 v18, 16, v85
v_and_b32 v19, 0xffff0000, v85
v_pk_mul_f32 v[18:19], v[18:19], s[50:51] op_sel_hi:[1,0]
v_cvt_pk_bf16_f32 v85, v18, v19
v_lshlrev_b32 v20, 16, v86
v_and_b32 v21, 0xffff0000, v86
v_pk_mul_f32 v[20:21], v[20:21], s[50:51] op_sel_hi:[1,0]
v_cvt_pk_bf16_f32 v86, v20, v21
v_lshlrev_b32 v22, 16, v87
v_and_b32 v23, 0xffff0000, v87
v_pk_mul_f32 v[22:23], v[22:23], s[50:51] op_sel_hi:[1,0]
v_cvt_pk_bf16_f32 v87, v22, v23
v_lshlrev_b32 v16, 16, v116
v_and_b32 v17, 0xffff0000, v116
v_pk_mul_f32 v[16:17], v[16:17], s[50:51] op_sel_hi:[1,0]
v_cvt_pk_bf16_f32 v116, v16, v17
v_lshlrev_b32 v18, 16, v117
v_and_b32 v19, 0xffff0000, v117
v_pk_mul_f32 v[18:19], v[18:19], s[50:51] op_sel_hi:[1,0]
v_cvt_pk_bf16_f32 v117, v18, v19
v_lshlrev_b32 v20, 16, v118
v_and_b32 v21, 0xffff0000, v118
v_pk_mul_f32 v[20:21], v[20:21], s[50:51] op_sel_hi:[1,0]
v_cvt_pk_bf16_f32 v118, v20, v21
v_lshlrev_b32 v22, 16, v119
v_and_b32 v23, 0xffff0000, v119
v_pk_mul_f32 v[22:23], v[22:23], s[50:51] op_sel_hi:[1,0]
v_cvt_pk_bf16_f32 v119, v22, v23
s_nop 0
v_mfma_f32_16x16x32_bf16 v[48:51], a[192:195], v[80:83], 0
v_mfma_f32_16x16x32_bf16 v[56:59], a[192:195], v[112:115], 0
v_mfma_f32_16x16x32_bf16 v[60:63], a[196:199], v[112:115], 0
v_mfma_f32_16x16x32_bf16 v[52:55], a[196:199], v[80:83], 0
v_mfma_f32_16x16x32_bf16 v[48:51], a[200:203], v[84:87], v[48:51]
v_mfma_f32_16x16x32_bf16 v[56:59], a[200:203], v[116:119], v[56:59]
v_mfma_f32_16x16x32_bf16 v[60:63], a[204:207], v[116:119], v[60:63]
v_mfma_f32_16x16x32_bf16 v[52:55], a[204:207], v[84:87], v[52:55]
s_waitcnt vmcnt(8)
ds_read_b128 a[224:227], v4 offset:8192
ds_read_b128 v[96:99], v148 offset:8192
ds_read_b128 a[228:231], v4 offset:10240
ds_read_b128 v[128:131], v148 offset:10240
ds_read_b128 a[232:235], v5 offset:8192
ds_read_b128 v[100:103], v149 offset:8192
ds_read_b128 a[236:239], v5 offset:10240
ds_read_b128 v[132:135], v149 offset:10240
s_add_u32 m0, s60, 0
s_nop 0
buffer_load_dwordx4 v3, s[20:23], s46 offen offset:0 nt lds
buffer_load_dwordx4 v3, s[20:23], s46 offen offset:1024 nt lds
buffer_load_dwordx4 v3, s[20:23], s46 offen offset:2048 nt lds
buffer_load_dwordx4 v3, s[20:23], s46 offen offset:3072 nt lds
s_add_u32 s46, s46, 0x4000
s_waitcnt lgkmcnt(8)
v_lshlrev_b32 v16, 16, v88
v_and_b32 v17, 0xffff0000, v88
v_pk_mul_f32 v[16:17], v[16:17], s[50:51] op_sel_hi:[1,0]
v_cvt_pk_bf16_f32 v88, v16, v17
v_lshlrev_b32 v18, 16, v89
v_and_b32 v19, 0xffff0000, v89
v_pk_mul_f32 v[18:19], v[18:19], s[50:51] op_sel_hi:[1,0]
v_cvt_pk_bf16_f32 v89, v18, v19
v_lshlrev_b32 v20, 16, v90
v_and_b32 v21, 0xffff0000, v90
v_pk_mul_f32 v[20:21], v[20:21], s[50:51] op_sel_hi:[1,0]
v_cvt_pk_bf16_f32 v90, v20, v21
v_lshlrev_b32 v22, 16, v91
v_and_b32 v23, 0xffff0000, v91
v_pk_mul_f32 v[22:23], v[22:23], s[50:51] op_sel_hi:[1,0]
v_cvt_pk_bf16_f32 v91, v22, v23
v_lshlrev_b32 v16, 16, v120
v_and_b32 v17, 0xffff0000, v120
v_pk_mul_f32 v[16:17], v[16:17], s[50:51] op_sel_hi:[1,0]
v_cvt_pk_bf16_f32 v120, v16, v17
v_lshlrev_b32 v18, 16, v121
v_and_b32 v19, 0xffff0000, v121
v_pk_mul_f32 v[18:19], v[18:19], s[50:51] op_sel_hi:[1,0]
v_cvt_pk_bf16_f32 v121, v18, v19
v_lshlrev_b32 v20, 16, v122
v_and_b32 v21, 0xffff0000, v122
v_pk_mul_f32 v[20:21], v[20:21], s[50:51] op_sel_hi:[1,0]
v_cvt_pk_bf16_f32 v122, v20, v21
v_lshlrev_b32 v22, 16, v123
v_and_b32 v23, 0xffff0000, v123
v_pk_mul_f32 v[22:23], v[22:23], s[50:51] op_sel_hi:[1,0]
v_cvt_pk_bf16_f32 v123, v22, v23
v_lshlrev_b32 v16, 16, v92
v_and_b32 v17, 0xffff0000, v92
v_pk_mul_f32 v[16:17], v[16:17], s[50:51] op_sel_hi:[1,0]
v_cvt_pk_bf16_f32 v92, v16, v17
v_lshlrev_b32 v18, 16, v93
v_and_b32 v19, 0xffff0000, v93
v_pk_mul_f32 v[18:19], v[18:19], s[50:51] op_sel_hi:[1,0]
v_cvt_pk_bf16_f32 v93, v18, v19
v_lshlrev_b32 v20, 16, v94
v_and_b32 v21, 0xffff0000, v94
v_pk_mul_f32 v[20:21], v[20:21], s[50:51] op_sel_hi:[1,0]
v_cvt_pk_bf16_f32 v94, v20, v21
v_lshlrev_b32 v22, 16, v95
v_and_b32 v23, 0xffff0000, v95
v_pk_mul_f32 v[22:23], v[22:23], s[50:51] op_sel_hi:[1,0]
v_cvt_pk_bf16_f32 v95, v22, v23
v_lshlrev_b32 v16, 16, v124
v_and_b32 v17, 0xffff0000, v124
v_pk_mul_f32 v[16:17], v[16:17], s[50:51] op_sel_hi:[1,0]
v_cvt_pk_bf16_f32 v124, v16, v17
v_lshlrev_b32 v18, 16, v125
v_and_b32 v19, 0xffff0000, v125
v_pk_mul_f32 v[18:19], v[18:19], s[50:51] op_sel_hi:[1,0]
v_cvt_pk_bf16_f32 v125, v18, v19
v_lshlrev_b32 v20, 16, v126
v_and_b32 v21, 0xffff0000, v126
v_pk_mul_f32 v[20:21], v[20:21], s[50:51] op_sel_hi:[1,0]
v_cvt_pk_bf16_f32 v126, v20, v21
v_lshlrev_b32 v22, 16, v127
v_and_b32 v23, 0xffff0000, v127
v_pk_mul_f32 v[22:23], v[22:23], s[50:51] op_sel_hi:[1,0]
v_cvt_pk_bf16_f32 v127, v22, v23
s_nop 0
v_mfma_f32_16x16x32_bf16 v[48:51], a[208:211], v[88:91], v[48:51]
v_mfma_f32_16x16x32_bf16 v[56:59], a[208:211], v[120:123], v[56:59]
v_mfma_f32_16x16x32_bf16 v[60:63], a[212:215], v[120:123], v[60:63]
v_mfma_f32_16x16x32_bf16 v[52:55], a[212:215], v[88:91], v[52:55]
v_mfma_f32_16x16x32_bf16 v[48:51], a[216:219], v[92:95], v[48:51]
v_mfma_f32_16x16x32_bf16 v[56:59], a[216:219], v[124:127], v[56:59]
v_mfma_f32_16x16x32_bf16 v[60:63], a[220:223], v[124:127], v[60:63]
v_mfma_f32_16x16x32_bf16 v[52:55], a[220:223], v[92:95], v[52:55]
s_waitcnt vmcnt(8)
ds_read_b128 a[240:243], v4 offset:12288
ds_read_b128 v[104:107], v148 offset:12288
ds_read_b128 a[244:247], v4 offset:14336
ds_read_b128 v[136:139], v148 offset:14336
ds_read_b128 a[248:251], v5 offset:12288
ds_read_b128 v[108:111], v149 offset:12288
ds_read_b128 a[252:255], v5 offset:14336
ds_read_b128 v[140:143], v149 offset:14336
s_add_u32 m0, s48, 0
s_nop 0
buffer_load_dwordx4 v1, s[16:19], s45 offen offset:0 nt lds
buffer_load_dwordx4 v2, s[16:19], s45 offen offset:1024 nt lds
buffer_load_dwordx4 v1, s[16:19], s45 offen offset:2048 nt lds
buffer_load_dwordx4 v2, s[16:19], s45 offen offset:3072 nt lds
s_add_u32 s45, s45, 0x4000
s_waitcnt lgkmcnt(8)
v_lshlrev_b32 v16, 16, v96
v_and_b32 v17, 0xffff0000, v96
v_pk_mul_f32 v[16:17], v[16:17], s[50:51] op_sel_hi:[1,0]
v_cvt_pk_bf16_f32 v96, v16, v17
v_lshlrev_b32 v18, 16, v97
v_and_b32 v19, 0xffff0000, v97
v_pk_mul_f32 v[18:19], v[18:19], s[50:51] op_sel_hi:[1,0]
v_cvt_pk_bf16_f32 v97, v18, v19
v_lshlrev_b32 v20, 16, v98
v_and_b32 v21, 0xffff0000, v98
v_pk_mul_f32 v[20:21], v[20:21], s[50:51] op_sel_hi:[1,0]
v_cvt_pk_bf16_f32 v98, v20, v21
v_lshlrev_b32 v22, 16, v99
v_and_b32 v23, 0xffff0000, v99
v_pk_mul_f32 v[22:23], v[22:23], s[50:51] op_sel_hi:[1,0]
v_cvt_pk_bf16_f32 v99, v22, v23
v_lshlrev_b32 v16, 16, v128
v_and_b32 v17, 0xffff0000, v128
v_pk_mul_f32 v[16:17], v[16:17], s[50:51] op_sel_hi:[1,0]
v_cvt_pk_bf16_f32 v128, v16, v17
v_lshlrev_b32 v18, 16, v129
v_and_b32 v19, 0xffff0000, v129
v_pk_mul_f32 v[18:19], v[18:19], s[50:51] op_sel_hi:[1,0]
v_cvt_pk_bf16_f32 v129, v18, v19
v_lshlrev_b32 v20, 16, v130
v_and_b32 v21, 0xffff0000, v130
v_pk_mul_f32 v[20:21], v[20:21], s[50:51] op_sel_hi:[1,0]
v_cvt_pk_bf16_f32 v130, v20, v21
v_lshlrev_b32 v22, 16, v131
v_and_b32 v23, 0xffff0000, v131
v_pk_mul_f32 v[22:23], v[22:23], s[50:51] op_sel_hi:[1,0]
v_cvt_pk_bf16_f32 v131, v22, v23
v_lshlrev_b32 v16, 16, v100
v_and_b32 v17, 0xffff0000, v100
v_pk_mul_f32 v[16:17], v[16:17], s[50:51] op_sel_hi:[1,0]
v_cvt_pk_bf16_f32 v100, v16, v17
v_lshlrev_b32 v18, 16, v101
v_and_b32 v19, 0xffff0000, v101
v_pk_mul_f32 v[18:19], v[18:19], s[50:51] op_sel_hi:[1,0]
v_cvt_pk_bf16_f32 v101, v18, v19
v_lshlrev_b32 v20, 16, v102
v_and_b32 v21, 0xffff0000, v102
v_pk_mul_f32 v[20:21], v[20:21], s[50:51] op_sel_hi:[1,0]
v_cvt_pk_bf16_f32 v102, v20, v21
v_lshlrev_b32 v22, 16, v103
v_and_b32 v23, 0xffff0000, v103
v_pk_mul_f32 v[22:23], v[22:23], s[50:51] op_sel_hi:[1,0]
v_cvt_pk_bf16_f32 v103, v22, v23
v_lshlrev_b32 v16, 16, v132
v_and_b32 v17, 0xffff0000, v132
v_pk_mul_f32 v[16:17], v[16:17], s[50:51] op_sel_hi:[1,0]
v_cvt_pk_bf16_f32 v132, v16, v17
v_lshlrev_b32 v18, 16, v133
v_and_b32 v19, 0xffff0000, v133
v_pk_mul_f32 v[18:19], v[18:19], s[50:51] op_sel_hi:[1,0]
v_cvt_pk_bf16_f32 v133, v18, v19
v_lshlrev_b32 v20, 16, v134
v_and_b32 v21, 0xffff0000, v134
v_pk_mul_f32 v[20:21], v[20:21], s[50:51] op_sel_hi:[1,0]
v_cvt_pk_bf16_f32 v134, v20, v21
v_lshlrev_b32 v22, 16, v135
v_and_b32 v23, 0xffff0000, v135
v_pk_mul_f32 v[22:23], v[22:23], s[50:51] op_sel_hi:[1,0]
v_cvt_pk_bf16_f32 v135, v22, v23
s_nop 0
v_mfma_f32_16x16x32_bf16 v[48:51], a[224:227], v[96:99], v[48:51]
v_mfma_f32_16x16x32_bf16 v[56:59], a[224:227], v[128:131], v[56:59]
v_mfma_f32_16x16x32_bf16 v[60:63], a[228:231], v[128:131], v[60:63]
v_mfma_f32_16x16x32_bf16 v[52:55], a[228:231], v[96:99], v[52:55]
v_mfma_f32_16x16x32_bf16 v[48:51], a[232:235], v[100:103], v[48:51]
v_mfma_f32_16x16x32_bf16 v[56:59], a[232:235], v[132:135], v[56:59]
v_mfma_f32_16x16x32_bf16 v[60:63], a[236:239], v[132:135], v[60:63]
v_mfma_f32_16x16x32_bf16 v[52:55], a[236:239], v[100:103], v[52:55]
s_cmp_lg_u32 s40, 0
s_cbranch_scc1 L_noflag1
s_mov_b32 s54, 0
L_prop:
s_add_u32 s54, s54, 1
v_cmp_eq_u32 vcc, s54, v144
s_cbranch_vccnz L_prop
v_mov_b32 v146, s54
v_mov_b32 v147, 0
s_lshl_b32 s53, s42, 2
v_mov_b32 v144, s53
s_mov_b64 exec, 1
global_atomic_cmpswap v223, v144, v[146:147], s[12:13] sc0
s_mov_b64 exec, -1
L_noflag1:
v_add_u32 v4, 0x4000, v4
v_add_u32 v5, 0x4000, v5
s_waitcnt lgkmcnt(0)
v_lshlrev_b32 v16, 16, v104
v_and_b32 v17, 0xffff0000, v104
v_pk_mul_f32 v[16:17], v[16:17], s[50:51] op_sel_hi:[1,0]
v_cvt_pk_bf16_f32 v104, v16, v17
v_lshlrev_b32 v18, 16, v105
v_and_b32 v19, 0xffff0000, v105
v_pk_mul_f32 v[18:19], v[18:19], s[50:51] op_sel_hi:[1,0]
v_cvt_pk_bf16_f32 v105, v18, v19
v_lshlrev_b32 v20, 16, v106
v_and_b32 v21, 0xffff0000, v106
v_pk_mul_f32 v[20:21], v[20:21], s[50:51] op_sel_hi:[1,0]
v_cvt_pk_bf16_f32 v106, v20, v21
v_lshlrev_b32 v22, 16, v107
v_and_b32 v23, 0xffff0000, v107
v_pk_mul_f32 v[22:23], v[22:23], s[50:51] op_sel_hi:[1,0]
v_cvt_pk_bf16_f32 v107, v22, v23
v_lshlrev_b32 v16, 16, v136
v_and_b32 v17, 0xffff0000, v136
v_pk_mul_f32 v[16:17], v[16:17], s[50:51] op_sel_hi:[1,0]
v_cvt_pk_bf16_f32 v136, v16, v17
v_lshlrev_b32 v18, 16, v137
v_and_b32 v19, 0xffff0000, v137
v_pk_mul_f32 v[18:19], v[18:19], s[50:51] op_sel_hi:[1,0]
v_cvt_pk_bf16_f32 v137, v18, v19
v_lshlrev_b32 v20, 16, v138
v_and_b32 v21, 0xffff0000, v138
v_pk_mul_f32 v[20:21], v[20:21], s[50:51] op_sel_hi:[1,0]
v_cvt_pk_bf16_f32 v138, v20, v21
v_lshlrev_b32 v22, 16, v139
v_and_b32 v23, 0xffff0000, v139
v_pk_mul_f32 v[22:23], v[22:23], s[50:51] op_sel_hi:[1,0]
v_cvt_pk_bf16_f32 v139, v22, v23
v_lshlrev_b32 v16, 16, v108
v_and_b32 v17, 0xffff0000, v108
v_pk_mul_f32 v[16:17], v[16:17], s[50:51] op_sel_hi:[1,0]
v_cvt_pk_bf16_f32 v108, v16, v17
v_lshlrev_b32 v18, 16, v109
v_and_b32 v19, 0xffff0000, v109
v_pk_mul_f32 v[18:19], v[18:19], s[50:51] op_sel_hi:[1,0]
v_cvt_pk_bf16_f32 v109, v18, v19
v_lshlrev_b32 v20, 16, v110
v_and_b32 v21, 0xffff0000, v110
v_pk_mul_f32 v[20:21], v[20:21], s[50:51] op_sel_hi:[1,0]
v_cvt_pk_bf16_f32 v110, v20, v21
v_lshlrev_b32 v22, 16, v111
v_and_b32 v23, 0xffff0000, v111
v_pk_mul_f32 v[22:23], v[22:23], s[50:51] op_sel_hi:[1,0]
v_cvt_pk_bf16_f32 v111, v22, v23
v_lshlrev_b32 v16, 16, v140
v_and_b32 v17, 0xffff0000, v140
v_pk_mul_f32 v[16:17], v[16:17], s[50:51] op_sel_hi:[1,0]
v_cvt_pk_bf16_f32 v140, v16, v17
v_lshlrev_b32 v18, 16, v141
v_and_b32 v19, 0xffff0000, v141
v_pk_mul_f32 v[18:19], v[18:19], s[50:51] op_sel_hi:[1,0]
v_cvt_pk_bf16_f32 v141, v18, v19
v_lshlrev_b32 v20, 16, v142
v_and_b32 v21, 0xffff0000, v142
v_pk_mul_f32 v[20:21], v[20:21], s[50:51] op_sel_hi:[1,0]
v_cvt_pk_bf16_f32 v142, v20, v21
v_lshlrev_b32 v22, 16, v143
v_and_b32 v23, 0xffff0000, v143
v_pk_mul_f32 v[22:23], v[22:23], s[50:51] op_sel_hi:[1,0]
v_cvt_pk_bf16_f32 v143, v22, v23
s_nop 0
v_mfma_f32_16x16x32_bf16 v[48:51], a[240:243], v[104:107], v[48:51]
v_mfma_f32_16x16x32_bf16 v[56:59], a[240:243], v[136:139], v[56:59]
v_mfma_f32_16x16x32_bf16 v[60:63], a[244:247], v[136:139], v[60:63]
v_mfma_f32_16x16x32_bf16 v[52:55], a[244:247], v[104:107], v[52:55]
v_mfma_f32_16x16x32_bf16 v[48:51], a[248:251], v[108:111], v[48:51]
v_mfma_f32_16x16x32_bf16 v[56:59], a[248:251], v[140:143], v[56:59]
v_mfma_f32_16x16x32_bf16 v[60:63], a[252:255], v[140:143], v[60:63]
v_mfma_f32_16x16x32_bf16 v[52:55], a[252:255], v[108:111], v[52:55]
s_waitcnt vmcnt(8)
s_barrier
ds_read_b128 a[192:195], v4 offset:0
ds_read_b128 a[196:199], v4 offset:2048
ds_read_b128 a[200:203], v5 offset:0
ds_read_b128 a[204:207], v5 offset:2048
ds_read_b128 a[208:211], v4 offset:4096
ds_read_b128 a[212:215], v4 offset:6144
ds_read_b128 a[216:219], v5 offset:4096
ds_read_b128 a[220:223], v5 offset:6144
ds_read_b128 a[224:227], v4 offset:8192
ds_read_b128 a[228:231], v4 offset:10240
ds_read_b128 a[232:235], v5 offset:8192
ds_read_b128 a[236:239], v5 offset:10240
ds_read_b128 a[240:243], v4 offset:12288
ds_read_b128 a[244:247], v4 offset:14336
ds_read_b128 a[248:251], v5 offset:12288
ds_read_b128 a[252:255], v5 offset:14336
s_add_u32 m0, s60, 8192
s_nop 0
buffer_load_dwordx4 v3, s[20:23], s46 offen offset:0 nt lds
buffer_load_dwordx4 v3, s[20:23], s46 offen offset:1024 nt lds
buffer_load_dwordx4 v3, s[20:23], s46 offen offset:2048 nt lds
buffer_load_dwordx4 v3, s[20:23], s46 offen offset:3072 nt lds
s_add_u32 s46, s46, 0x4000
s_add_u32 m0, s48, 16384
s_nop 0
buffer_load_dwordx4 v1, s[16:19], s45 offen offset:0 nt lds
buffer_load_dwordx4 v2, s[16:19], s45 offen offset:1024 nt lds
buffer_load_dwordx4 v1, s[16:19], s45 offen offset:2048 nt lds
buffer_load_dwordx4 v2, s[16:19], s45 offen offset:3072 nt lds
s_add_u32 s45, s45, 0x4000
v_add_u32 v4, 0xffff8000, v4
v_add_u32 v5, 0xffff8000, v5
s_add_u32 s48, s48, 32768
s_add_u32 s60, s60, 16384
s_mov_b32 m0, s60
s_mov_b32 s49, 13
s_mov_b32 s43, 114688
s_mov_b32 s42, s43
v_max3_f32 v10, v48, v49, v50
v_max3_f32 v10, v10, v51, v52
v_max3_f32 v10, v10, v53, v54
v_max_f32 v10, v10, v55
v_mov_b32 v16, v10
s_nop 1
v_permlane32_swap_b32 v16, v10
v_max_f32 v10, v10, v16
v_mov_b32 v16, v10
s_nop 1
v_permlane16_swap_b32 v16, v10
v_max_f32 v10, v10, v16
v_ceil_f32 v10, v10
v_sub_f32 v48, v48, v10
v_sub_f32 v49, v49, v10
v_sub_f32 v50, v50, v10
v_sub_f32 v51, v51, v10
v_sub_f32 v52, v52, v10
v_sub_f32 v53, v53, v10
v_sub_f32 v54, v54, v10
v_sub_f32 v55, v55, v10
v_sub_f32 v248, 0, v10
v_sub_f32 v249, 0, v10
v_sub_f32 v250, 0, v10
v_sub_f32 v251, 0, v10
v_max3_f32 v11, v56, v57, v58
v_max3_f32 v11, v11, v59, v60
v_max3_f32 v11, v11, v61, v62
v_max_f32 v11, v11, v63
v_mov_b32 v16, v11
s_nop 1
v_permlane32_swap_b32 v16, v11
v_max_f32 v11, v11, v16
v_mov_b32 v16, v11
s_nop 1
v_permlane16_swap_b32 v16, v11
v_max_f32 v11, v11, v16
v_ceil_f32 v11, v11
v_sub_f32 v56, v56, v11
v_sub_f32 v57, v57, v11
v_sub_f32 v58, v58, v11
v_sub_f32 v59, v59, v11
v_sub_f32 v60, v60, v11
v_sub_f32 v61, v61, v11
v_sub_f32 v62, v62, v11
v_sub_f32 v63, v63, v11
v_sub_f32 v252, 0, v11
v_sub_f32 v253, 0, v11
v_sub_f32 v254, 0, v11
v_sub_f32 v255, 0, v11
v_exp_f32 v16, v48
v_exp_f32 v17, v49
v_exp_f32 v18, v50
v_exp_f32 v19, v51
v_exp_f32 v20, v52
v_exp_f32 v21, v53
v_exp_f32 v22, v54
v_exp_f32 v23, v55
v_exp_f32 v24, v56
v_exp_f32 v25, v57
v_exp_f32 v26, v58
v_exp_f32 v27, v59
v_exp_f32 v28, v60
v_exp_f32 v29, v61
s_nop 0
v_add_f32 v12, v14, v16
v_cvt_pk_bf16_f32 v32, v16, v17
v_cvt_pk_bf16_f32 v33, v18, v19
v_cvt_pk_bf16_f32 v34, v20, v21
v_cvt_pk_bf16_f32 v35, v22, v23
v_cvt_pk_bf16_f32 v36, v24, v25
s_waitcnt lgkmcnt(0)
.p2align 6
L_loop:
v_mfma_f32_16x16x32_bf16 v[64:67], a[192:195], v[80:83], v[248:251]
s_waitcnt vmcnt(8)
s_barrier
buffer_load_dwordx4 v3, s[20:23], s46 offen offset:0 nt lds
v_mfma_f32_16x16x32_bf16 v[72:75], a[192:195], v[112:115], v[252:255]
s_add_u32 s60, s60, 0x2000
ds_read_b64_tr_b16 a[128:129], v6 offset:0
ds_read_b64_tr_b16 a[130:131], v6 offset:2048
v_mfma_f32_16x16x32_bf16 v[76:79], a[196:199], v[112:115], v[252:255]
s_sub_u32 s67, s60, s62
ds_read_b64_tr_b16 a[132:133], v7 offset:0
v_cvt_pk_bf16_f32 v37, v26, v27
v_mfma_f32_16x16x32_bf16 v[68:71], a[196:199], v[80:83], v[248:251]
s_cmp_ge_u32 s60, s61
v_exp_f32 v30, v62
v_mfma_f32_16x16x32_bf16 v[64:67], a[200:203], v[84:87], v[64:67]
s_cselect_b32 s60, s67, s60
ds_read_b64_tr_b16 a[134:135], v7 offset:2048
v_cvt_pk_bf16_f32 v38, v28, v29
v_mfma_f32_16x16x32_bf16 v[72:75], a[200:203], v[116:119], v[72:75]
s_add_u32 s53, s47, 0x2000
ds_read_b64_tr_b16 a[136:137], v8 offset:0
v_add_f32 v12, v12, v17
v_mfma_f32_16x16x32_bf16 v[76:79], a[204:207], v[116:119], v[76:79]
s_cmp_eq_u32 s53, 0x6000
buffer_load_dwordx4 v3, s[20:23], s46 offen offset:1024 nt lds
v_mfma_f32_16x16x32_bf16 v[68:71], a[204:207], v[84:87], v[68:71]
s_cselect_b32 s53, 0, s53
ds_read_b64_tr_b16 a[138:139], v8 offset:2048
ds_read_b64_tr_b16 a[140:141], v9 offset:0
v_mfma_f32_16x16x32_bf16 v[64:67], a[208:211], v[88:91], v[64:67]
s_sub_u32 s52, s53, s47
ds_read_b64_tr_b16 a[142:143], v9 offset:2048
v_add_f32 v12, v12, v18
v_mfma_f32_16x16x32_bf16 v[72:75], a[208:211], v[120:123], v[72:75]
s_mov_b32 s47, s53
v_exp_f32 v31, v63
v_mfma_f32_16x16x32_bf16 v[76:79], a[212:215], v[120:123], v[76:79]
s_lshl_b32 s55, s52, 1
ds_read_b64_tr_b16 a[144:145], v6 offset:4096
v_cvt_pk_bf16_f32 v39, v30, v31
v_mfma_f32_16x16x32_bf16 v[68:71], a[212:215], v[88:91], v[68:71]
ds_read_b64_tr_b16 a[146:147], v6 offset:6144
v_add_f32 v12, v12, v19
v_mfma_f32_16x16x32_bf16 v[64:67], a[216:219], v[92:95], v[64:67]
ds_read_b64_tr_b16 a[148:149], v7 offset:4096
v_add_f32 v12, v12, v20
v_mfma_f32_16x16x32_bf16 v[72:75], a[216:219], v[124:127], v[72:75]
ds_read_b64_tr_b16 a[150:151], v7 offset:6144
v_add_f32 v12, v12, v21
v_mfma_f32_16x16x32_bf16 v[76:79], a[220:223], v[124:127], v[76:79]
buffer_load_dwordx4 v3, s[20:23], s46 offen offset:2048 nt lds
v_mfma_f32_16x16x32_bf16 v[68:71], a[220:223], v[92:95], v[68:71]
ds_read_b64_tr_b16 a[152:153], v8 offset:4096
v_add_f32 v12, v12, v22
v_mfma_f32_16x16x32_bf16 v[64:67], a[224:227], v[96:99], v[64:67]
ds_read_b64_tr_b16 a[154:155], v8 offset:6144
v_add_f32 v12, v12, v23
v_mfma_f32_16x16x32_bf16 v[72:75], a[224:227], v[128:131], v[72:75]
ds_read_b64_tr_b16 a[156:157], v9 offset:4096
v_add_f32 v13, v15, v24
v_mfma_f32_16x16x32_bf16 v[76:79], a[228:231], v[128:131], v[76:79]
ds_read_b64_tr_b16 a[158:159], v9 offset:6144
v_add_f32 v13, v13, v25
v_mfma_f32_16x16x32_bf16 v[68:71], a[228:231], v[96:99], v[68:71]
ds_read_b64_tr_b16 a[160:161], v6 offset:24576
v_add_f32 v13, v13, v26
v_mfma_f32_16x16x32_bf16 v[64:67], a[232:235], v[100:103], v[64:67]
buffer_load_dwordx4 v3, s[20:23], s46 offen offset:3072 nt lds
v_mfma_f32_16x16x32_bf16 v[72:75], a[232:235], v[132:135], v[72:75]
s_add_u32 s46, s46, 0x4000
ds_read_b64_tr_b16 a[162:163], v6 offset:26624
v_add_f32 v13, v13, v27
v_mfma_f32_16x16x32_bf16 v[76:79], a[236:239], v[132:135], v[76:79]
s_cmp_lt_u32 s100, s43
ds_read_b64_tr_b16 a[164:165], v7 offset:24576
v_add_f32 v13, v13, v28
v_mfma_f32_16x16x32_bf16 v[68:71], a[236:239], v[100:103], v[68:71]
s_cbranch_scc1 L_extra0
L_extra0_back:
ds_read_b64_tr_b16 a[166:167], v7 offset:26624
v_add_f32 v13, v13, v29
v_mfma_f32_16x16x32_bf16 v[64:67], a[240:243], v[104:107], v[64:67]
ds_read_b64_tr_b16 a[168:169], v8 offset:24576
v_add_f32 v13, v13, v30
v_mfma_f32_16x16x32_bf16 v[72:75], a[240:243], v[136:139], v[72:75]
ds_read_b64_tr_b16 a[170:171], v8 offset:26624
v_add_f32 v13, v13, v31
v_mfma_f32_16x16x32_bf16 v[76:79], a[244:247], v[136:139], v[76:79]
ds_read_b64_tr_b16 a[172:173], v9 offset:24576
v_max_f32 v16, v12, v13
v_mfma_f32_16x16x32_bf16 v[68:71], a[244:247], v[104:107], v[68:71]
ds_read_b64_tr_b16 a[174:175], v9 offset:26624
v_cmp_lt_f32 vcc, s51, v16
v_mfma_f32_16x16x32_bf16 v[64:67], a[248:251], v[108:111], v[64:67]
ds_read_b64_tr_b16 a[176:177], v6 offset:28672
ds_read_b64_tr_b16 a[178:179], v6 offset:30720
v_mfma_f32_16x16x32_bf16 v[72:75], a[248:251], v[140:143], v[72:75]
s_mov_b32 m0, s48
ds_read_b64_tr_b16 a[180:181], v7 offset:28672
ds_read_b64_tr_b16 a[182:183], v7 offset:30720
v_mfma_f32_16x16x32_bf16 v[76:79], a[252:255], v[140:143], v[76:79]
s_cbranch_vccnz L_rare_e
L_back_e:
ds_read_b64_tr_b16 a[184:185], v8 offset:28672
ds_read_b64_tr_b16 a[186:187], v8 offset:30720
v_mfma_f32_16x16x32_bf16 v[68:71], a[252:255], v[108:111], v[68:71]
s_waitcnt lgkmcnt(15)
ds_read_b64_tr_b16 a[188:189], v9 offset:28672
ds_read_b64_tr_b16 a[190:191], v9 offset:30720
s_cmp_eq_u32 s49, 1
s_cbranch_scc1 L_trans
v_mfma_f32_16x16x32_bf16 a[0:3], a[128:131], v[32:35], a[0:3]
s_add_u32 s48, s48, 0x4000
buffer_load_dwordx4 v1, s[16:19], s45 offen offset:0 nt lds
v_mfma_f32_16x16x32_bf16 a[4:7], a[128:131], v[36:39], a[4:7]
s_sub_u32 s67, s48, 0xc000
ds_read_b128 a[192:195], v4 offset:0
ds_read_b128 a[196:199], v4 offset:2048
v_mfma_f32_16x16x32_bf16 a[12:15], a[132:135], v[36:39], a[12:15]
s_cmp_ge_u32 s48, 0x28000
ds_read_b128 a[200:203], v5 offset:0
ds_read_b128 a[204:207], v5 offset:2048
v_mfma_f32_16x16x32_bf16 a[8:11], a[132:135], v[32:35], a[8:11]
s_cselect_b32 s48, s67, s48
v_exp_f32 v16, v64
v_mfma_f32_16x16x32_bf16 a[16:19], a[136:139], v[32:35], a[16:19]
ds_read_b128 a[208:211], v4 offset:4096
v_add_f32 v14, v12, v16
v_mfma_f32_16x16x32_bf16 a[20:23], a[136:139], v[36:39], a[20:23]
v_exp_f32 v17, v65
v_mfma_f32_16x16x32_bf16 a[28:31], a[140:143], v[36:39], a[28:31]
ds_read_b128 a[212:215], v4 offset:6144
v_cvt_pk_bf16_f32 v40, v16, v17
v_mfma_f32_16x16x32_bf16 a[24:27], a[140:143], v[32:35], a[24:27]
s_waitcnt lgkmcnt(15)
v_exp_f32 v18, v66
v_mfma_f32_16x16x32_bf16 a[32:35], a[144:147], v[32:35], a[32:35]
buffer_load_dwordx4 v2, s[16:19], s45 offen offset:1024 nt lds
v_mfma_f32_16x16x32_bf16 a[36:39], a[144:147], v[36:39], a[36:39]
v_exp_f32 v19, v67
v_mfma_f32_16x16x32_bf16 a[44:47], a[148:151], v[36:39], a[44:47]
ds_read_b128 a[216:219], v5 offset:4096
ds_read_b128 a[220:223], v5 offset:6144
v_mfma_f32_16x16x32_bf16 a[40:43], a[148:151], v[32:35], a[40:43]
v_exp_f32 v20, v68
v_mfma_f32_16x16x32_bf16 a[48:51], a[152:155], v[32:35], a[48:51]
ds_read_b128 a[224:227], v4 offset:8192
v_cvt_pk_bf16_f32 v41, v18, v19
v_mfma_f32_16x16x32_bf16 a[52:55], a[152:155], v[36:39], a[52:55]
v_exp_f32 v21, v69
v_mfma_f32_16x16x32_bf16 a[60:63], a[156:159], v[36:39], a[60:63]
ds_read_b128 a[228:231], v4 offset:10240
v_cvt_pk_bf16_f32 v42, v20, v21
v_mfma_f32_16x16x32_bf16 a[56:59], a[156:159], v[32:35], a[56:59]
s_waitcnt lgkmcnt(15)
v_exp_f32 v22, v70
v_mfma_f32_16x16x32_bf16 a[64:67], a[160:163], v[32:35], a[64:67]
buffer_load_dwordx4 v1, s[16:19], s45 offen offset:2048 nt lds
v_mfma_f32_16x16x32_bf16 a[68:71], a[160:163], v[36:39], a[68:71]
v_exp_f32 v23, v71
v_mfma_f32_16x16x32_bf16 a[76:79], a[164:167], v[36:39], a[76:79]
ds_read_b128 a[232:235], v5 offset:8192
ds_read_b128 a[236:239], v5 offset:10240
v_mfma_f32_16x16x32_bf16 a[72:75], a[164:167], v[32:35], a[72:75]
v_exp_f32 v24, v72
v_mfma_f32_16x16x32_bf16 a[80:83], a[168:171], v[32:35], a[80:83]
ds_read_b128 a[240:243], v4 offset:12288
v_cvt_pk_bf16_f32 v43, v22, v23
v_mfma_f32_16x16x32_bf16 a[84:87], a[168:171], v[36:39], a[84:87]
v_exp_f32 v25, v73
v_mfma_f32_16x16x32_bf16 a[92:95], a[172:175], v[36:39], a[92:95]
buffer_load_dwordx4 v2, s[16:19], s45 offen offset:3072 nt lds
v_mfma_f32_16x16x32_bf16 a[88:91], a[172:175], v[32:35], a[88:91]
s_waitcnt lgkmcnt(13)
v_exp_f32 v26, v74
v_mfma_f32_16x16x32_bf16 a[96:99], a[176:179], v[32:35], a[96:99]
s_add_u32 s45, s45, 0x4000
ds_read_b128 a[244:247], v4 offset:14336
ds_read_b128 a[248:251], v5 offset:12288
v_mfma_f32_16x16x32_bf16 a[100:103], a[176:179], v[36:39], a[100:103]
s_mov_b32 m0, s60
v_exp_f32 v27, v75
v_mfma_f32_16x16x32_bf16 a[108:111], a[180:183], v[36:39], a[108:111]
ds_read_b128 a[252:255], v5 offset:14336
v_add_u32 v6, s52, v6
v_mfma_f32_16x16x32_bf16 a[104:107], a[180:183], v[32:35], a[104:107]
v_exp_f32 v28, v76
v_mfma_f32_16x16x32_bf16 a[112:115], a[184:187], v[32:35], a[112:115]
v_add_u32 v4, s55, v4
v_add_u32 v5, s55, v5
v_mfma_f32_16x16x32_bf16 a[116:119], a[184:187], v[36:39], a[116:119]
v_exp_f32 v29, v77
v_mfma_f32_16x16x32_bf16 a[124:127], a[188:191], v[36:39], a[124:127]
v_add_u32 v7, s52, v7
v_add_u32 v8, s52, v8
v_mfma_f32_16x16x32_bf16 a[120:123], a[188:191], v[32:35], a[120:123]
s_waitcnt lgkmcnt(0)
v_add_u32 v9, s52, v9
v_cvt_pk_bf16_f32 v44, v24, v25
v_mfma_f32_16x16x32_bf16 v[48:51], a[192:195], v[80:83], v[248:251]
s_waitcnt vmcnt(8)
s_barrier
buffer_load_dwordx4 v3, s[20:23], s46 offen offset:0 nt lds
v_mfma_f32_16x16x32_bf16 v[56:59], a[192:195], v[112:115], v[252:255]
s_add_u32 s60, s60, 0x2000
ds_read_b64_tr_b16 a[128:129], v6 offset:0
ds_read_b64_tr_b16 a[130:131], v6 offset:2048
v_mfma_f32_16x16x32_bf16 v[60:63], a[196:199], v[112:115], v[252:255]
s_sub_u32 s67, s60, s62
ds_read_b64_tr_b16 a[132:133], v7 offset:0
v_cvt_pk_bf16_f32 v45, v26, v27
v_mfma_f32_16x16x32_bf16 v[52:55], a[196:199], v[80:83], v[248:251]
s_cmp_ge_u32 s60, s61
v_exp_f32 v30, v78
v_mfma_f32_16x16x32_bf16 v[48:51], a[200:203], v[84:87], v[48:51]
s_cselect_b32 s60, s67, s60
ds_read_b64_tr_b16 a[134:135], v7 offset:2048
v_cvt_pk_bf16_f32 v46, v28, v29
v_mfma_f32_16x16x32_bf16 v[56:59], a[200:203], v[116:119], v[56:59]
s_add_u32 s53, s47, 0x2000
ds_read_b64_tr_b16 a[136:137], v8 offset:0
v_add_f32 v14, v14, v17
v_mfma_f32_16x16x32_bf16 v[60:63], a[204:207], v[116:119], v[60:63]
s_cmp_eq_u32 s53, 0x6000
buffer_load_dwordx4 v3, s[20:23], s46 offen offset:1024 nt lds
v_mfma_f32_16x16x32_bf16 v[52:55], a[204:207], v[84:87], v[52:55]
s_cselect_b32 s53, 0, s53
ds_read_b64_tr_b16 a[138:139], v8 offset:2048
ds_read_b64_tr_b16 a[140:141], v9 offset:0
v_mfma_f32_16x16x32_bf16 v[48:51], a[208:211], v[88:91], v[48:51]
s_sub_u32 s52, s53, s47
ds_read_b64_tr_b16 a[142:143], v9 offset:2048
v_add_f32 v14, v14, v18
v_mfma_f32_16x16x32_bf16 v[56:59], a[208:211], v[120:123], v[56:59]
s_mov_b32 s47, s53
v_exp_f32 v31, v79
v_mfma_f32_16x16x32_bf16 v[60:63], a[212:215], v[120:123], v[60:63]
s_lshl_b32 s55, s52, 1
ds_read_b64_tr_b16 a[144:145], v6 offset:4096
v_cvt_pk_bf16_f32 v47, v30, v31
v_mfma_f32_16x16x32_bf16 v[52:55], a[212:215], v[88:91], v[52:55]
s_sub_u32 s49, s49, 1
ds_read_b64_tr_b16 a[146:147], v6 offset:6144
v_add_f32 v14, v14, v19
v_mfma_f32_16x16x32_bf16 v[48:51], a[216:219], v[92:95], v[48:51]
s_cmp_eq_u32 s49, 2
ds_read_b64_tr_b16 a[148:149], v7 offset:4096
v_add_f32 v14, v14, v20
v_mfma_f32_16x16x32_bf16 v[56:59], a[216:219], v[124:127], v[56:59]
s_cselect_b32 s63, s64, 0
ds_read_b64_tr_b16 a[150:151], v7 offset:6144
v_add_f32 v14, v14, v21
v_mfma_f32_16x16x32_bf16 v[60:63], a[220:223], v[124:127], v[60:63]
s_add_u32 s60, s60, s63
buffer_load_dwordx4 v3, s[20:23], s46 offen offset:2048 nt lds
v_mfma_f32_16x16x32_bf16 v[52:55], a[220:223], v[92:95], v[52:55]
s_add_u32 s61, s61, s63
ds_read_b64_tr_b16 a[152:153], v8 offset:4096
v_add_f32 v14, v14, v22
v_mfma_f32_16x16x32_bf16 v[48:51], a[224:227], v[96:99], v[48:51]
s_lshl_b32 s63, s63, 3
ds_read_b64_tr_b16 a[154:155], v8 offset:6144
v_add_f32 v14, v14, v23
v_mfma_f32_16x16x32_bf16 v[56:59], a[224:227], v[128:131], v[56:59]
s_add_u32 s63, s63, 0x4000
ds_read_b64_tr_b16 a[156:157], v9 offset:4096
v_add_f32 v15, v13, v24
v_mfma_f32_16x16x32_bf16 v[60:63], a[228:231], v[128:131], v[60:63]
ds_read_b64_tr_b16 a[158:159], v9 offset:6144
v_add_f32 v15, v15, v25
v_mfma_f32_16x16x32_bf16 v[52:55], a[228:231], v[96:99], v[52:55]
ds_read_b64_tr_b16 a[160:161], v6 offset:24576
v_add_f32 v15, v15, v26
v_mfma_f32_16x16x32_bf16 v[48:51], a[232:235], v[100:103], v[48:51]
buffer_load_dwordx4 v3, s[20:23], s46 offen offset:3072 nt lds
v_mfma_f32_16x16x32_bf16 v[56:59], a[232:235], v[132:135], v[56:59]
s_add_u32 s46, s46, s63
ds_read_b64_tr_b16 a[162:163], v6 offset:26624
v_add_f32 v15, v15, v27
v_mfma_f32_16x16x32_bf16 v[60:63], a[236:239], v[132:135], v[60:63]
s_cmp_lt_u32 s100, s43
ds_read_b64_tr_b16 a[164:165], v7 offset:24576
v_add_f32 v15, v15, v28
v_mfma_f32_16x16x32_bf16 v[52:55], a[236:239], v[100:103], v[52:55]
s_cbranch_scc1 L_extra1
L_extra1_back:
ds_read_b64_tr_b16 a[166:167], v7 offset:26624
v_add_f32 v15, v15, v29
v_mfma_f32_16x16x32_bf16 v[48:51], a[240:243], v[104:107], v[48:51]
ds_read_b64_tr_b16 a[168:169], v8 offset:24576
v_add_f32 v15, v15, v30
v_mfma_f32_16x16x32_bf16 v[56:59], a[240:243], v[136:139], v[56:59]
ds_read_b64_tr_b16 a[170:171], v8 offset:26624
v_add_f32 v15, v15, v31
v_mfma_f32_16x16x32_bf16 v[60:63], a[244:247], v[136:139], v[60:63]
ds_read_b64_tr_b16 a[172:173], v9 offset:24576
v_max_f32 v16, v14, v15
v_mfma_f32_16x16x32_bf16 v[52:55], a[244:247], v[104:107], v[52:55]
ds_read_b64_tr_b16 a[174:175], v9 offset:26624
v_cmp_lt_f32 vcc, s51, v16
v_mfma_f32_16x16x32_bf16 v[48:51], a[248:251], v[108:111], v[48:51]
ds_read_b64_tr_b16 a[176:177], v6 offset:28672
ds_read_b64_tr_b16 a[178:179], v6 offset:30720
v_mfma_f32_16x16x32_bf16 v[56:59], a[248:251], v[140:143], v[56:59]
s_mov_b32 m0, s48
ds_read_b64_tr_b16 a[180:181], v7 offset:28672
ds_read_b64_tr_b16 a[182:183], v7 offset:30720
v_mfma_f32_16x16x32_bf16 v[60:63], a[252:255], v[140:143], v[60:63]
s_cbranch_vccnz L_rare_o
L_back_o:
ds_read_b64_tr_b16 a[184:185], v8 offset:28672
ds_read_b64_tr_b16 a[186:187], v8 offset:30720
v_mfma_f32_16x16x32_bf16 v[52:55], a[252:255], v[108:111], v[52:55]
s_waitcnt lgkmcnt(15)
ds_read_b64_tr_b16 a[188:189], v9 offset:28672
ds_read_b64_tr_b16 a[190:191], v9 offset:30720
v_mfma_f32_16x16x32_bf16 a[0:3], a[128:131], v[40:43], a[0:3]
s_add_u32 s48, s48, 0x4000
buffer_load_dwordx4 v1, s[16:19], s45 offen offset:0 nt lds
v_mfma_f32_16x16x32_bf16 a[4:7], a[128:131], v[44:47], a[4:7]
s_sub_u32 s67, s48, 0xc000
ds_read_b128 a[192:195], v4 offset:0
ds_read_b128 a[196:199], v4 offset:2048
v_mfma_f32_16x16x32_bf16 a[12:15], a[132:135], v[44:47], a[12:15]
s_cmp_ge_u32 s48, 0x28000
ds_read_b128 a[200:203], v5 offset:0
ds_read_b128 a[204:207], v5 offset:2048
v_mfma_f32_16x16x32_bf16 a[8:11], a[132:135], v[40:43], a[8:11]
s_cselect_b32 s48, s67, s48
v_exp_f32 v16, v48
v_mfma_f32_16x16x32_bf16 a[16:19], a[136:139], v[40:43], a[16:19]
s_add_u32 s68, s3, 0x6000
ds_read_b128 a[208:211], v4 offset:4096
v_add_f32 v12, v14, v16
v_mfma_f32_16x16x32_bf16 a[20:23], a[136:139], v[44:47], a[20:23]
s_cmp_eq_u32 s49, 2
v_exp_f32 v17, v49
v_mfma_f32_16x16x32_bf16 a[28:31], a[140:143], v[44:47], a[28:31]
s_cselect_b32 s65, s101, s65
ds_read_b128 a[212:215], v4 offset:6144
v_cvt_pk_bf16_f32 v32, v16, v17
v_mfma_f32_16x16x32_bf16 a[24:27], a[140:143], v[40:43], a[24:27]
s_waitcnt lgkmcnt(15)
v_exp_f32 v18, v50
v_mfma_f32_16x16x32_bf16 a[32:35], a[144:147], v[40:43], a[32:35]
s_cselect_b32 s100, s68, s100
buffer_load_dwordx4 v2, s[16:19], s45 offen offset:1024 nt lds
v_mfma_f32_16x16x32_bf16 a[36:39], a[144:147], v[44:47], a[36:39]
s_cselect_b32 s43, 0xc000, s43
v_exp_f32 v19, v51
v_mfma_f32_16x16x32_bf16 a[44:47], a[148:151], v[44:47], a[44:47]
s_cselect_b32 s42, 0, s42
ds_read_b128 a[216:219], v5 offset:4096
ds_read_b128 a[220:223], v5 offset:6144
v_mfma_f32_16x16x32_bf16 a[40:43], a[148:151], v[40:43], a[40:43]
v_exp_f32 v20, v52
v_mfma_f32_16x16x32_bf16 a[48:51], a[152:155], v[40:43], a[48:51]
ds_read_b128 a[224:227], v4 offset:8192
v_cvt_pk_bf16_f32 v33, v18, v19
v_mfma_f32_16x16x32_bf16 a[52:55], a[152:155], v[44:47], a[52:55]
v_exp_f32 v21, v53
v_mfma_f32_16x16x32_bf16 a[60:63], a[156:159], v[44:47], a[60:63]
ds_read_b128 a[228:231], v4 offset:10240
v_cvt_pk_bf16_f32 v34, v20, v21
v_mfma_f32_16x16x32_bf16 a[56:59], a[156:159], v[40:43], a[56:59]
s_waitcnt lgkmcnt(15)
v_exp_f32 v22, v54
v_mfma_f32_16x16x32_bf16 a[64:67], a[160:163], v[40:43], a[64:67]
buffer_load_dwordx4 v1, s[16:19], s45 offen offset:2048 nt lds
v_mfma_f32_16x16x32_bf16 a[68:71], a[160:163], v[44:47], a[68:71]
v_exp_f32 v23, v55
v_mfma_f32_16x16x32_bf16 a[76:79], a[164:167], v[44:47], a[76:79]
ds_read_b128 a[232:235], v5 offset:8192
ds_read_b128 a[236:239], v5 offset:10240
v_mfma_f32_16x16x32_bf16 a[72:75], a[164:167], v[40:43], a[72:75]
v_exp_f32 v24, v56
v_mfma_f32_16x16x32_bf16 a[80:83], a[168:171], v[40:43], a[80:83]
ds_read_b128 a[240:243], v4 offset:12288
v_cvt_pk_bf16_f32 v35, v22, v23
v_mfma_f32_16x16x32_bf16 a[84:87], a[168:171], v[44:47], a[84:87]
v_exp_f32 v25, v57
v_mfma_f32_16x16x32_bf16 a[92:95], a[172:175], v[44:47], a[92:95]
buffer_load_dwordx4 v2, s[16:19], s45 offen offset:3072 nt lds
v_mfma_f32_16x16x32_bf16 a[88:91], a[172:175], v[40:43], a[88:91]
s_waitcnt lgkmcnt(13)
v_exp_f32 v26, v58
v_mfma_f32_16x16x32_bf16 a[96:99], a[176:179], v[40:43], a[96:99]
s_add_u32 s45, s45, 0x4000
ds_read_b128 a[244:247], v4 offset:14336
ds_read_b128 a[248:251], v5 offset:12288
v_mfma_f32_16x16x32_bf16 a[100:103], a[176:179], v[44:47], a[100:103]
s_mov_b32 m0, s60
v_exp_f32 v27, v59
v_mfma_f32_16x16x32_bf16 a[108:111], a[180:183], v[44:47], a[108:111]
ds_read_b128 a[252:255], v5 offset:14336
v_add_u32 v6, s52, v6
v_mfma_f32_16x16x32_bf16 a[104:107], a[180:183], v[40:43], a[104:107]
v_exp_f32 v28, v60
v_mfma_f32_16x16x32_bf16 a[112:115], a[184:187], v[40:43], a[112:115]
v_add_u32 v4, s55, v4
v_add_u32 v5, s55, v5
v_mfma_f32_16x16x32_bf16 a[116:119], a[184:187], v[44:47], a[116:119]
v_exp_f32 v29, v61
v_mfma_f32_16x16x32_bf16 a[124:127], a[188:191], v[44:47], a[124:127]
v_add_u32 v7, s52, v7
v_add_u32 v8, s52, v8
v_mfma_f32_16x16x32_bf16 a[120:123], a[188:191], v[40:43], a[120:123]
s_waitcnt lgkmcnt(0)
v_add_u32 v9, s52, v9
v_cvt_pk_bf16_f32 v36, v24, v25
s_branch L_loop
L_trans:
ds_read_b128 a[192:195], v4 offset:0
ds_read_b128 a[196:199], v4 offset:2048
ds_read_b128 a[200:203], v5 offset:0
ds_read_b128 a[204:207], v5 offset:2048
ds_read_b128 a[208:211], v4 offset:4096
ds_read_b128 a[212:215], v4 offset:6144
ds_read_b128 a[216:219], v5 offset:4096
ds_read_b128 a[220:223], v5 offset:6144
buffer_load_dwordx4 v1, s[16:19], s45 offen offset:0 nt lds
buffer_load_dwordx4 v2, s[16:19], s45 offen offset:1024 nt lds
buffer_load_dwordx4 v1, s[16:19], s45 offen offset:2048 nt lds
buffer_load_dwordx4 v2, s[16:19], s45 offen offset:3072 nt lds
s_add_u32 s45, s45, 0x4000
s_add_u32 s48, s48, 0x4000
s_sub_u32 s67, s48, 0xc000
s_cmp_ge_u32 s48, 0x28000
s_cselect_b32 s48, s67, s48
s_mov_b32 s46, s65
s_mov_b32 s60, s3
s_add_u32 s61, s3, 0xc000
s_mov_b32 s62, 0xc000
s_lshl_b32 s95, s47, 1
v_readfirstlane_b32 s69, v223
v_mov_b32 v144, v32
v_mov_b32 v145, v33
v_mov_b32 v146, v34
v_mov_b32 v147, v35
v_mov_b32 v148, v36
v_mov_b32 v149, v37
v_mov_b32 v150, v38
v_mov_b32 v151, v39
s_mov_b32 s49, 4
.p2align 6
L_loop2:
v_mfma_f32_16x16x32_bf16 a[0:3], a[128:131], v[32:35], a[0:3]
s_mov_b32 m0, s60
ds_read_b128 a[224:227], v4 offset:8192
ds_read_b128 a[228:231], v4 offset:10240
v_mfma_f32_16x16x32_bf16 a[4:7], a[128:131], v[36:39], a[4:7]
ds_read_b128 a[232:235], v5 offset:8192
ds_read_b128 a[236:239], v5 offset:10240
v_mfma_f32_16x16x32_bf16 a[12:15], a[132:135], v[36:39], a[12:15]
ds_read_b128 a[240:243], v4 offset:12288
ds_read_b128 a[244:247], v4 offset:14336
v_mfma_f32_16x16x32_bf16 a[8:11], a[132:135], v[32:35], a[8:11]
v_exp_f32 v16, v64
v_mfma_f32_16x16x32_bf16 a[16:19], a[136:139], v[32:35], a[16:19]
v_exp_f32 v17, v65
v_mfma_f32_16x16x32_bf16 a[20:23], a[136:139], v[36:39], a[20:23]
v_exp_f32 v18, v66
v_mfma_f32_16x16x32_bf16 a[28:31], a[140:143], v[36:39], a[28:31]
ds_read_b128 a[248:251], v5 offset:12288
v_cvt_pk_bf16_f32 v40, v16, v17
v_mfma_f32_16x16x32_bf16 a[24:27], a[140:143], v[32:35], a[24:27]
s_waitcnt lgkmcnt(7)
v_exp_f32 v19, v67
v_mfma_f32_16x16x32_bf16 a[32:35], a[144:147], v[32:35], a[32:35]
v_add_u32 v6, s52, v6
v_exp_f32 v20, v68
v_mfma_f32_16x16x32_bf16 a[36:39], a[144:147], v[36:39], a[36:39]
v_add_u32 v7, s52, v7
v_cvt_pk_bf16_f32 v41, v18, v19
v_mfma_f32_16x16x32_bf16 a[44:47], a[148:151], v[36:39], a[44:47]
ds_read_b128 a[252:255], v5 offset:14336
v_add_u32 v8, s52, v8
v_mfma_f32_16x16x32_bf16 a[40:43], a[148:151], v[32:35], a[40:43]
v_add_u32 v9, s52, v9
v_add_f32 v14, v12, v16
v_mfma_f32_16x16x32_bf16 a[48:51], a[152:155], v[32:35], a[48:51]
v_exp_f32 v21, v69
v_mfma_f32_16x16x32_bf16 a[52:55], a[152:155], v[36:39], a[52:55]
v_add_u32 v4, s55, v4
v_exp_f32 v22, v70
v_mfma_f32_16x16x32_bf16 a[60:63], a[156:159], v[36:39], a[60:63]
v_add_u32 v5, s55, v5
v_cvt_pk_bf16_f32 v42, v20, v21
v_mfma_f32_16x16x32_bf16 a[56:59], a[156:159], v[32:35], a[56:59]
s_waitcnt lgkmcnt(0)
v_exp_f32 v23, v71
s_cmp_eq_u32 s49, 1
s_cbranch_scc1 L_fin
v_mfma_f32_16x16x32_bf16 v[48:51], a[192:195], v[80:83], v[248:251]
s_waitcnt vmcnt(6)
s_barrier
buffer_load_dwordx4 v3, s[20:23], s46 offen offset:0 nt lds
ds_read_b64_tr_b16 a[128:129], v6 offset:0
v_mfma_f32_16x16x32_bf16 v[56:59], a[192:195], v[112:115], v[252:255]
ds_read_b64_tr_b16 a[130:131], v6 offset:2048
ds_read_b64_tr_b16 a[132:133], v7 offset:0
v_mfma_f32_16x16x32_bf16 v[60:63], a[196:199], v[112:115], v[252:255]
buffer_load_dwordx4 v3, s[20:23], s46 offen offset:1024 nt lds
v_exp_f32 v24, v72
v_mfma_f32_16x16x32_bf16 v[52:55], a[196:199], v[80:83], v[248:251]
s_mov_b32 m0, s48
ds_read_b64_tr_b16 a[134:135], v7 offset:2048
ds_read_b64_tr_b16 a[136:137], v8 offset:0
v_mfma_f32_16x16x32_bf16 v[48:51], a[200:203], v[84:87], v[48:51]
s_add_u32 s60, s60, 0x2000
v_exp_f32 v25, v73
v_mfma_f32_16x16x32_bf16 v[56:59], a[200:203], v[116:119], v[56:59]
s_sub_u32 s67, s60, s62
buffer_load_dwordx4 v1, s[16:19], s45 offen offset:0 nt lds
v_cvt_pk_bf16_f32 v43, v22, v23
v_mfma_f32_16x16x32_bf16 v[60:63], a[204:207], v[116:119], v[60:63]
s_cmp_ge_u32 s60, s61
v_exp_f32 v26, v74
v_mfma_f32_16x16x32_bf16 v[52:55], a[204:207], v[84:87], v[52:55]
s_cselect_b32 s60, s67, s60
ds_read_b64_tr_b16 a[138:139], v8 offset:2048
ds_read_b64_tr_b16 a[140:141], v9 offset:0
v_cvt_pk_bf16_f32 v44, v24, v25
v_mfma_f32_16x16x32_bf16 v[48:51], a[208:211], v[88:91], v[48:51]
s_add_u32 s53, s47, 0x2000
buffer_load_dwordx4 v2, s[16:19], s45 offen offset:1024 nt lds
v_add_f32 v14, v14, v17
v_mfma_f32_16x16x32_bf16 v[56:59], a[208:211], v[120:123], v[56:59]
s_cmp_eq_u32 s53, 0xc000
ds_read_b64_tr_b16 a[142:143], v9 offset:2048
v_add_f32 v14, v14, v18
v_mfma_f32_16x16x32_bf16 v[60:63], a[212:215], v[120:123], v[60:63]
s_cselect_b32 s53, 0, s53
ds_read_b128 a[192:195], v4 offset:0
v_add_f32 v14, v14, v19
v_mfma_f32_16x16x32_bf16 v[52:55], a[212:215], v[88:91], v[52:55]
s_sub_u32 s52, s53, s47
buffer_load_dwordx4 v1, s[16:19], s45 offen offset:2048 nt lds
v_add_f32 v14, v14, v20
v_mfma_f32_16x16x32_bf16 v[48:51], a[216:219], v[92:95], v[48:51]
s_mov_b32 s47, s53
v_exp_f32 v27, v75
v_add_f32 v14, v14, v21
v_mfma_f32_16x16x32_bf16 v[56:59], a[216:219], v[124:127], v[56:59]
s_add_u32 s53, s95, 0x4000
ds_read_b128 a[196:199], v4 offset:2048
v_cvt_pk_bf16_f32 v45, v26, v27
v_mfma_f32_16x16x32_bf16 v[60:63], a[220:223], v[124:127], v[60:63]
s_cmp_eq_u32 s53, 0xc000
buffer_load_dwordx4 v2, s[16:19], s45 offen offset:3072 nt lds
v_add_f32 v14, v14, v22
v_mfma_f32_16x16x32_bf16 v[52:55], a[220:223], v[92:95], v[52:55]
s_cselect_b32 s53, 0, s53
v_exp_f32 v28, v76
v_mfma_f32_16x16x32_bf16 v[48:51], a[224:227], v[96:99], v[48:51]
s_sub_u32 s55, s53, s95
ds_read_b128 a[200:203], v5 offset:0
v_add_f32 v14, v14, v23
v_mfma_f32_16x16x32_bf16 v[56:59], a[224:227], v[128:131], v[56:59]
s_mov_b32 s95, s53
v_exp_f32 v29, v77
v_add_f32 v15, v13, v24
v_mfma_f32_16x16x32_bf16 v[60:63], a[228:231], v[128:131], v[60:63]
s_add_u32 s48, s48, 0x4000
ds_read_b128 a[204:207], v5 offset:2048
v_cvt_pk_bf16_f32 v46, v28, v29
v_mfma_f32_16x16x32_bf16 v[52:55], a[228:231], v[96:99], v[52:55]
s_sub_u32 s67, s48, 0xc000
v_exp_f32 v30, v78
v_mfma_f32_16x16x32_bf16 v[48:51], a[232:235], v[100:103], v[48:51]
s_cmp_ge_u32 s48, 0x28000
ds_read_b128 a[208:211], v4 offset:4096
v_add_f32 v15, v15, v25
v_mfma_f32_16x16x32_bf16 v[56:59], a[232:235], v[132:135], v[56:59]
s_cselect_b32 s48, s67, s48
v_exp_f32 v31, v79
v_mfma_f32_16x16x32_bf16 v[60:63], a[236:239], v[132:135], v[60:63]
s_add_u32 s45, s45, 0x4000
ds_read_b128 a[212:215], v4 offset:6144
v_cvt_pk_bf16_f32 v47, v30, v31
v_add_f32 v15, v15, v26
v_mfma_f32_16x16x32_bf16 v[52:55], a[236:239], v[100:103], v[52:55]
s_sub_u32 s49, s49, 1
v_add_f32 v15, v15, v27
v_add_f32 v15, v15, v28
v_mfma_f32_16x16x32_bf16 v[48:51], a[240:243], v[104:107], v[48:51]
s_add_u32 s46, s46, 0x4000
ds_read_b128 a[216:219], v5 offset:4096
v_add_f32 v15, v15, v29
v_mfma_f32_16x16x32_bf16 v[56:59], a[240:243], v[136:139], v[56:59]
v_add_f32 v15, v15, v30
v_add_f32 v15, v15, v31
v_mfma_f32_16x16x32_bf16 v[60:63], a[244:247], v[136:139], v[60:63]
ds_read_b128 a[220:223], v5 offset:6144
v_max_f32 v16, v14, v15
v_mfma_f32_16x16x32_bf16 v[52:55], a[244:247], v[104:107], v[52:55]
ds_read_b64_tr_b16 a[144:145], v6 offset:4096
ds_read_b64_tr_b16 a[146:147], v6 offset:6144
v_cmp_lt_f32 vcc, s51, v16
v_mfma_f32_16x16x32_bf16 v[48:51], a[248:251], v[108:111], v[48:51]
ds_read_b64_tr_b16 a[148:149], v7 offset:4096
ds_read_b64_tr_b16 a[150:151], v7 offset:6144
v_mfma_f32_16x16x32_bf16 v[56:59], a[248:251], v[140:143], v[56:59]
ds_read_b64_tr_b16 a[152:153], v8 offset:4096
ds_read_b64_tr_b16 a[154:155], v8 offset:6144
v_mfma_f32_16x16x32_bf16 v[60:63], a[252:255], v[140:143], v[60:63]
s_cbranch_vccnz L_rare_o2
L_back_o2:
ds_read_b64_tr_b16 a[156:157], v9 offset:4096
ds_read_b64_tr_b16 a[158:159], v9 offset:6144
v_mfma_f32_16x16x32_bf16 v[52:55], a[252:255], v[108:111], v[52:55]
s_waitcnt lgkmcnt(15)
s_set_gpr_idx_on s66, 0x8
v_mov_b32 v144, v40
v_mov_b32 v145, v41
v_mov_b32 v146, v42
v_mov_b32 v147, v43
v_mov_b32 v148, v44
v_mov_b32 v149, v45
v_mov_b32 v150, v46
v_mov_b32 v151, v47
s_set_gpr_idx_off
s_add_u32 s66, s66, 8
v_mfma_f32_16x16x32_bf16 a[0:3], a[128:131], v[40:43], a[0:3]
s_mov_b32 m0, s60
ds_read_b128 a[224:227], v4 offset:8192
ds_read_b128 a[228:231], v4 offset:10240
v_mfma_f32_16x16x32_bf16 a[4:7], a[128:131], v[44:47], a[4:7]
ds_read_b128 a[232:235], v5 offset:8192
ds_read_b128 a[236:239], v5 offset:10240
v_mfma_f32_16x16x32_bf16 a[12:15], a[132:135], v[44:47], a[12:15]
ds_read_b128 a[240:243], v4 offset:12288
ds_read_b128 a[244:247], v4 offset:14336
v_mfma_f32_16x16x32_bf16 a[8:11], a[132:135], v[40:43], a[8:11]
v_exp_f32 v16, v48
v_mfma_f32_16x16x32_bf16 a[16:19], a[136:139], v[40:43], a[16:19]
v_exp_f32 v17, v49
v_mfma_f32_16x16x32_bf16 a[20:23], a[136:139], v[44:47], a[20:23]
v_exp_f32 v18, v50
v_mfma_f32_16x16x32_bf16 a[28:31], a[140:143], v[44:47], a[28:31]
ds_read_b128 a[248:251], v5 offset:12288
v_cvt_pk_bf16_f32 v32, v16, v17
v_mfma_f32_16x16x32_bf16 a[24:27], a[140:143], v[40:43], a[24:27]
s_waitcnt lgkmcnt(7)
v_exp_f32 v19, v51
v_mfma_f32_16x16x32_bf16 a[32:35], a[144:147], v[40:43], a[32:35]
v_add_u32 v6, s52, v6
v_exp_f32 v20, v52
v_mfma_f32_16x16x32_bf16 a[36:39], a[144:147], v[44:47], a[36:39]
v_add_u32 v7, s52, v7
v_cvt_pk_bf16_f32 v33, v18, v19
v_mfma_f32_16x16x32_bf16 a[44:47], a[148:151], v[44:47], a[44:47]
ds_read_b128 a[252:255], v5 offset:14336
v_add_u32 v8, s52, v8
v_mfma_f32_16x16x32_bf16 a[40:43], a[148:151], v[40:43], a[40:43]
v_add_u32 v9, s52, v9
v_add_f32 v12, v14, v16
v_mfma_f32_16x16x32_bf16 a[48:51], a[152:155], v[40:43], a[48:51]
v_exp_f32 v21, v53
v_mfma_f32_16x16x32_bf16 a[52:55], a[152:155], v[44:47], a[52:55]
v_add_u32 v4, s55, v4
v_exp_f32 v22, v54
v_mfma_f32_16x16x32_bf16 a[60:63], a[156:159], v[44:47], a[60:63]
v_add_u32 v5, s55, v5
v_cvt_pk_bf16_f32 v34, v20, v21
v_mfma_f32_16x16x32_bf16 a[56:59], a[156:159], v[40:43], a[56:59]
s_waitcnt lgkmcnt(0)
v_exp_f32 v23, v55
v_mfma_f32_16x16x32_bf16 v[64:67], a[192:195], v[80:83], v[248:251]
s_waitcnt vmcnt(6)
s_barrier
buffer_load_dwordx4 v3, s[20:23], s46 offen offset:0 nt lds
ds_read_b64_tr_b16 a[128:129], v6 offset:0
v_mfma_f32_16x16x32_bf16 v[72:75], a[192:195], v[112:115], v[252:255]
ds_read_b64_tr_b16 a[130:131], v6 offset:2048
ds_read_b64_tr_b16 a[132:133], v7 offset:0
v_mfma_f32_16x16x32_bf16 v[76:79], a[196:199], v[112:115], v[252:255]
buffer_load_dwordx4 v3, s[20:23], s46 offen offset:1024 nt lds
v_exp_f32 v24, v56
v_mfma_f32_16x16x32_bf16 v[68:71], a[196:199], v[80:83], v[248:251]
s_mov_b32 m0, s48
ds_read_b64_tr_b16 a[134:135], v7 offset:2048
ds_read_b64_tr_b16 a[136:137], v8 offset:0
v_mfma_f32_16x16x32_bf16 v[64:67], a[200:203], v[84:87], v[64:67]
s_add_u32 s60, s60, 0x2000
v_exp_f32 v25, v57
v_mfma_f32_16x16x32_bf16 v[72:75], a[200:203], v[116:119], v[72:75]
s_sub_u32 s67, s60, s62
buffer_load_dwordx4 v1, s[16:19], s45 offen offset:0 nt lds
v_cvt_pk_bf16_f32 v35, v22, v23
v_mfma_f32_16x16x32_bf16 v[76:79], a[204:207], v[116:119], v[76:79]
s_cmp_ge_u32 s60, s61
v_exp_f32 v26, v58
v_mfma_f32_16x16x32_bf16 v[68:71], a[204:207], v[84:87], v[68:71]
s_cselect_b32 s60, s67, s60
ds_read_b64_tr_b16 a[138:139], v8 offset:2048
ds_read_b64_tr_b16 a[140:141], v9 offset:0
v_cvt_pk_bf16_f32 v36, v24, v25
v_mfma_f32_16x16x32_bf16 v[64:67], a[208:211], v[88:91], v[64:67]
s_add_u32 s53, s47, 0x2000
buffer_load_dwordx4 v2, s[16:19], s45 offen offset:1024 nt lds
v_add_f32 v12, v12, v17
v_mfma_f32_16x16x32_bf16 v[72:75], a[208:211], v[120:123], v[72:75]
s_cmp_eq_u32 s53, 0xc000
ds_read_b64_tr_b16 a[142:143], v9 offset:2048
v_add_f32 v12, v12, v18
v_mfma_f32_16x16x32_bf16 v[76:79], a[212:215], v[120:123], v[76:79]
s_cselect_b32 s53, 0, s53
ds_read_b128 a[192:195], v4 offset:0
v_add_f32 v12, v12, v19
v_mfma_f32_16x16x32_bf16 v[68:71], a[212:215], v[88:91], v[68:71]
s_sub_u32 s52, s53, s47
buffer_load_dwordx4 v1, s[16:19], s45 offen offset:2048 nt lds
v_add_f32 v12, v12, v20
v_mfma_f32_16x16x32_bf16 v[64:67], a[216:219], v[92:95], v[64:67]
s_mov_b32 s47, s53
v_exp_f32 v27, v59
v_add_f32 v12, v12, v21
v_mfma_f32_16x16x32_bf16 v[72:75], a[216:219], v[124:127], v[72:75]
s_add_u32 s53, s95, 0x4000
ds_read_b128 a[196:199], v4 offset:2048
v_cvt_pk_bf16_f32 v37, v26, v27
v_mfma_f32_16x16x32_bf16 v[76:79], a[220:223], v[124:127], v[76:79]
s_cmp_eq_u32 s53, 0xc000
buffer_load_dwordx4 v2, s[16:19], s45 offen offset:3072 nt lds
v_add_f32 v12, v12, v22
v_mfma_f32_16x16x32_bf16 v[68:71], a[220:223], v[92:95], v[68:71]
s_cselect_b32 s53, 0, s53
v_exp_f32 v28, v60
v_mfma_f32_16x16x32_bf16 v[64:67], a[224:227], v[96:99], v[64:67]
s_sub_u32 s55, s53, s95
ds_read_b128 a[200:203], v5 offset:0
v_add_f32 v12, v12, v23
v_mfma_f32_16x16x32_bf16 v[72:75], a[224:227], v[128:131], v[72:75]
s_mov_b32 s95, s53
v_exp_f32 v29, v61
v_add_f32 v13, v15, v24
v_mfma_f32_16x16x32_bf16 v[76:79], a[228:231], v[128:131], v[76:79]
s_add_u32 s48, s48, 0x4000
ds_read_b128 a[204:207], v5 offset:2048
v_cvt_pk_bf16_f32 v38, v28, v29
v_mfma_f32_16x16x32_bf16 v[68:71], a[228:231], v[96:99], v[68:71]
s_sub_u32 s67, s48, 0xc000
v_exp_f32 v30, v62
v_mfma_f32_16x16x32_bf16 v[64:67], a[232:235], v[100:103], v[64:67]
s_cmp_ge_u32 s48, 0x28000
ds_read_b128 a[208:211], v4 offset:4096
v_add_f32 v13, v13, v25
v_mfma_f32_16x16x32_bf16 v[72:75], a[232:235], v[132:135], v[72:75]
s_cselect_b32 s48, s67, s48
v_exp_f32 v31, v63
v_mfma_f32_16x16x32_bf16 v[76:79], a[236:239], v[132:135], v[76:79]
s_add_u32 s45, s45, 0x4000
ds_read_b128 a[212:215], v4 offset:6144
v_cvt_pk_bf16_f32 v39, v30, v31
v_add_f32 v13, v13, v26
v_mfma_f32_16x16x32_bf16 v[68:71], a[236:239], v[100:103], v[68:71]
s_add_u32 s46, s46, 0x4000
v_add_f32 v13, v13, v27
v_add_f32 v13, v13, v28
v_mfma_f32_16x16x32_bf16 v[64:67], a[240:243], v[104:107], v[64:67]
ds_read_b128 a[216:219], v5 offset:4096
v_add_f32 v13, v13, v29
v_mfma_f32_16x16x32_bf16 v[72:75], a[240:243], v[136:139], v[72:75]
v_add_f32 v13, v13, v30
v_add_f32 v13, v13, v31
v_mfma_f32_16x16x32_bf16 v[76:79], a[244:247], v[136:139], v[76:79]
ds_read_b128 a[220:223], v5 offset:6144
v_max_f32 v16, v12, v13
v_mfma_f32_16x16x32_bf16 v[68:71], a[244:247], v[104:107], v[68:71]
ds_read_b64_tr_b16 a[144:145], v6 offset:4096
ds_read_b64_tr_b16 a[146:147], v6 offset:6144
v_cmp_lt_f32 vcc, s51, v16
v_mfma_f32_16x16x32_bf16 v[64:67], a[248:251], v[108:111], v[64:67]
ds_read_b64_tr_b16 a[148:149], v7 offset:4096
ds_read_b64_tr_b16 a[150:151], v7 offset:6144
v_mfma_f32_16x16x32_bf16 v[72:75], a[248:251], v[140:143], v[72:75]
ds_read_b64_tr_b16 a[152:153], v8 offset:4096
ds_read_b64_tr_b16 a[154:155], v8 offset:6144
v_mfma_f32_16x16x32_bf16 v[76:79], a[252:255], v[140:143], v[76:79]
s_cbranch_vccnz L_rare_e2
L_back_e2:
ds_read_b64_tr_b16 a[156:157], v9 offset:4096
ds_read_b64_tr_b16 a[158:159], v9 offset:6144
v_mfma_f32_16x16x32_bf16 v[68:71], a[252:255], v[108:111], v[68:71]
s_waitcnt lgkmcnt(15)
s_set_gpr_idx_on s66, 0x8
v_mov_b32 v144, v32
v_mov_b32 v145, v33
v_mov_b32 v146, v34
v_mov_b32 v147, v35
v_mov_b32 v148, v36
v_mov_b32 v149, v37
v_mov_b32 v150, v38
v_mov_b32 v151, v39
s_set_gpr_idx_off
s_add_u32 s66, s66, 8
s_branch L_loop2
L_fin:
ds_read_b64_tr_b16 a[128:129], v6 offset:0
ds_read_b64_tr_b16 a[130:131], v6 offset:2048
ds_read_b64_tr_b16 a[132:133], v7 offset:0
ds_read_b64_tr_b16 a[134:135], v7 offset:2048
ds_read_b64_tr_b16 a[136:137], v8 offset:0
ds_read_b64_tr_b16 a[138:139], v8 offset:2048
ds_read_b64_tr_b16 a[140:141], v9 offset:0
ds_read_b64_tr_b16 a[142:143], v9 offset:2048
ds_read_b64_tr_b16 a[144:145], v6 offset:4096
ds_read_b64_tr_b16 a[146:147], v6 offset:6144
ds_read_b64_tr_b16 a[148:149], v7 offset:4096
ds_read_b64_tr_b16 a[150:151], v7 offset:6144
ds_read_b64_tr_b16 a[152:153], v8 offset:4096
ds_read_b64_tr_b16 a[154:155], v8 offset:6144
ds_read_b64_tr_b16 a[156:157], v9 offset:4096
ds_read_b64_tr_b16 a[158:159], v9 offset:6144
v_exp_f32 v24, v72
v_add_f32 v14, v14, v17
v_add_f32 v14, v14, v18
v_exp_f32 v25, v73
v_add_f32 v14, v14, v19
v_add_f32 v14, v14, v20
v_exp_f32 v26, v74
v_add_f32 v14, v14, v21
v_add_f32 v14, v14, v22
v_exp_f32 v27, v75
v_add_f32 v14, v14, v23
v_add_f32 v15, v13, v24
v_exp_f32 v28, v76
v_add_f32 v15, v15, v25
v_add_f32 v15, v15, v26
v_exp_f32 v29, v77
v_add_f32 v15, v15, v27
v_add_f32 v15, v15, v28
v_exp_f32 v30, v78
v_add_f32 v15, v15, v29
v_cvt_pk_bf16_f32 v43, v22, v23
v_exp_f32 v31, v79
v_add_f32 v15, v15, v30
v_cvt_pk_bf16_f32 v44, v24, v25
s_nop 0
v_add_f32 v15, v15, v31
v_cvt_pk_bf16_f32 v45, v26, v27
v_cvt_pk_bf16_f32 v46, v28, v29
v_cvt_pk_bf16_f32 v47, v30, v31
v_max_f32 v16, v14, v15
v_cmp_lt_f32 vcc, s51, v16
s_mov_b32 s53, 0x2000
s_mov_b32 s67, 0x1000
s_cbranch_vccnz L_rare_f
L_back_f:
s_waitcnt lgkmcnt(8)
v_mfma_f32_16x16x32_bf16 a[0:3], a[128:131], v[40:43], a[0:3]
v_lshlrev_b32 v48, 4, v0
v_mov_b32 v56, v10
v_mov_b32 v57, v11
v_mov_b32 v58, v14
v_mfma_f32_16x16x32_bf16 a[4:7], a[128:131], v[44:47], a[4:7]
v_mov_b32 v59, v15
v_mov_b32 v52, v58
s_nop 1
v_permlane32_swap_b32 v52, v58
v_mfma_f32_16x16x32_bf16 a[12:15], a[132:135], v[44:47], a[12:15]
v_add_f32 v58, v58, v52
v_mov_b32 v52, v58
s_nop 1
v_permlane16_swap_b32 v52, v58
v_mfma_f32_16x16x32_bf16 a[8:11], a[132:135], v[40:43], a[8:11]
v_add_f32 v58, v58, v52
v_mov_b32 v53, v59
s_nop 1
v_permlane32_swap_b32 v53, v59
v_mfma_f32_16x16x32_bf16 a[16:19], a[136:139], v[40:43], a[16:19]
v_add_f32 v59, v59, v53
v_mov_b32 v53, v59
s_nop 1
v_permlane16_swap_b32 v53, v59
v_mfma_f32_16x16x32_bf16 a[20:23], a[136:139], v[44:47], a[20:23]
v_add_f32 v59, v59, v53
v_and_b32 v50, 0xf0, v48
buffer_store_dwordx4 v[56:59], v50, s[32:35], s53 offen sc1
v_accvgpr_read_b32 v16, a0
v_accvgpr_read_b32 v17, a1
v_mfma_f32_16x16x32_bf16 a[28:31], a[140:143], v[44:47], a[28:31]
v_accvgpr_read_b32 v18, a2
v_accvgpr_read_b32 v19, a3
v_cvt_pk_bf16_f32 v64, v16, v17
v_cvt_pk_bf16_f32 v65, v18, v19
v_accvgpr_read_b32 v20, a4
v_mfma_f32_16x16x32_bf16 a[24:27], a[140:143], v[40:43], a[24:27]
s_waitcnt lgkmcnt(0)
v_accvgpr_read_b32 v21, a5
v_accvgpr_read_b32 v22, a6
v_accvgpr_read_b32 v23, a7
v_cvt_pk_bf16_f32 v66, v20, v21
v_cvt_pk_bf16_f32 v67, v22, v23
v_mfma_f32_16x16x32_bf16 a[32:35], a[144:147], v[40:43], a[32:35]
buffer_store_dwordx4 v[64:67], v48, s[32:35], 0 offen offset:0 sc1
v_accvgpr_read_b32 v24, a8
v_accvgpr_read_b32 v25, a9
v_accvgpr_read_b32 v26, a10
v_accvgpr_read_b32 v27, a11
v_mfma_f32_16x16x32_bf16 a[36:39], a[144:147], v[44:47], a[36:39]
v_cvt_pk_bf16_f32 v68, v24, v25
v_cvt_pk_bf16_f32 v69, v26, v27
v_accvgpr_read_b32 v28, a12
v_accvgpr_read_b32 v29, a13
v_accvgpr_read_b32 v30, a14
v_mfma_f32_16x16x32_bf16 a[44:47], a[148:151], v[44:47], a[44:47]
v_accvgpr_read_b32 v31, a15
v_cvt_pk_bf16_f32 v70, v28, v29
v_cvt_pk_bf16_f32 v71, v30, v31
buffer_store_dwordx4 v[68:71], v48, s[32:35], 0 offen offset:1024 sc1
v_accvgpr_read_b32 v16, a16
v_mfma_f32_16x16x32_bf16 a[40:43], a[148:151], v[40:43], a[40:43]
v_accvgpr_read_b32 v17, a17
v_accvgpr_read_b32 v18, a18
v_accvgpr_read_b32 v19, a19
v_cvt_pk_bf16_f32 v72, v16, v17
v_cvt_pk_bf16_f32 v73, v18, v19
v_mfma_f32_16x16x32_bf16 a[48:51], a[152:155], v[40:43], a[48:51]
v_accvgpr_read_b32 v20, a20
v_accvgpr_read_b32 v21, a21
v_accvgpr_read_b32 v22, a22
v_accvgpr_read_b32 v23, a23
v_cvt_pk_bf16_f32 v74, v20, v21
v_mfma_f32_16x16x32_bf16 a[52:55], a[152:155], v[44:47], a[52:55]
v_cvt_pk_bf16_f32 v75, v22, v23
buffer_store_dwordx4 v[72:75], v48, s[32:35], 0 offen offset:2048 sc1
v_accvgpr_read_b32 v24, a24
v_accvgpr_read_b32 v25, a25
v_accvgpr_read_b32 v26, a26
v_mfma_f32_16x16x32_bf16 a[60:63], a[156:159], v[44:47], a[60:63]
v_accvgpr_read_b32 v27, a27
v_cvt_pk_bf16_f32 v76, v24, v25
v_cvt_pk_bf16_f32 v77, v26, v27
v_accvgpr_read_b32 v28, a28
v_accvgpr_read_b32 v29, a29
v_mfma_f32_16x16x32_bf16 a[56:59], a[156:159], v[40:43], a[56:59]
v_accvgpr_read_b32 v30, a30
v_accvgpr_read_b32 v31, a31
v_cvt_pk_bf16_f32 v78, v28, v29
v_cvt_pk_bf16_f32 v79, v30, v31
buffer_store_dwordx4 v[76:79], v48, s[32:35], 0 offen offset:3072 sc1
v_accvgpr_read_b32 v16, a32
v_accvgpr_read_b32 v17, a33
v_accvgpr_read_b32 v18, a34
v_accvgpr_read_b32 v19, a35
v_cvt_pk_bf16_f32 v64, v16, v17
v_cvt_pk_bf16_f32 v65, v18, v19
v_accvgpr_read_b32 v20, a36
v_accvgpr_read_b32 v21, a37
v_accvgpr_read_b32 v22, a38
v_accvgpr_read_b32 v23, a39
v_cvt_pk_bf16_f32 v66, v20, v21
v_cvt_pk_bf16_f32 v67, v22, v23
buffer_store_dwordx4 v[64:67], v48, s[32:35], s67 offen offset:0 sc1
v_accvgpr_read_b32 v24, a40
v_accvgpr_read_b32 v25, a41
v_accvgpr_read_b32 v26, a42
v_accvgpr_read_b32 v27, a43
v_cvt_pk_bf16_f32 v68, v24, v25
v_cvt_pk_bf16_f32 v69, v26, v27
v_accvgpr_read_b32 v28, a44
v_accvgpr_read_b32 v29, a45
v_accvgpr_read_b32 v30, a46
v_accvgpr_read_b32 v31, a47
v_cvt_pk_bf16_f32 v70, v28, v29
v_cvt_pk_bf16_f32 v71, v30, v31
buffer_store_dwordx4 v[68:71], v48, s[32:35], s67 offen offset:1024 sc1
s_nop 0
v_accvgpr_read_b32 v16, a48
v_accvgpr_read_b32 v17, a49
v_accvgpr_read_b32 v18, a50
v_accvgpr_read_b32 v19, a51
v_cvt_pk_bf16_f32 v72, v16, v17
v_cvt_pk_bf16_f32 v73, v18, v19
v_accvgpr_read_b32 v20, a52
v_accvgpr_read_b32 v21, a53
v_accvgpr_read_b32 v22, a54
v_accvgpr_read_b32 v23, a55
v_cvt_pk_bf16_f32 v74, v20, v21
v_cvt_pk_bf16_f32 v75, v22, v23
buffer_store_dwordx4 v[72:75], v48, s[32:35], s67 offen offset:2048 sc1
v_accvgpr_read_b32 v24, a56
v_accvgpr_read_b32 v25, a57
v_accvgpr_read_b32 v26, a58
v_accvgpr_read_b32 v27, a59
v_cvt_pk_bf16_f32 v76, v24, v25
v_cvt_pk_bf16_f32 v77, v26, v27
v_accvgpr_read_b32 v28, a60
v_accvgpr_read_b32 v29, a61
v_accvgpr_read_b32 v30, a62
v_accvgpr_read_b32 v31, a63
v_cvt_pk_bf16_f32 v78, v28, v29
v_cvt_pk_bf16_f32 v79, v30, v31
buffer_store_dwordx4 v[76:79], v48, s[32:35], s67 offen offset:3072 sc1
s_mov_b32 s68, s47
v_subrev_u32 v6, s68, v6
v_subrev_u32 v7, s68, v7
v_subrev_u32 v8, s68, v8
v_subrev_u32 v9, s68, v9
v_add_u32 v60, 0x10000, v6
v_add_u32 v61, 0x10000, v7
v_add_u32 v62, 0x10000, v8
v_add_u32 v63, 0x10000, v9
ds_read_b64_tr_b16 a[128:129], v6 offset:49152
ds_read_b64_tr_b16 a[130:131], v6 offset:51200
ds_read_b64_tr_b16 a[132:133], v6 offset:57344
ds_read_b64_tr_b16 a[134:135], v6 offset:59392
ds_read_b64_tr_b16 a[136:137], v60 offset:0
ds_read_b64_tr_b16 a[138:139], v60 offset:2048
ds_read_b64_tr_b16 a[140:141], v60 offset:8192
ds_read_b64_tr_b16 a[142:143], v60 offset:10240
ds_read_b64_tr_b16 a[144:145], v60 offset:16384
ds_read_b64_tr_b16 a[146:147], v60 offset:18432
ds_read_b64_tr_b16 a[148:149], v60 offset:24576
ds_read_b64_tr_b16 a[150:151], v60 offset:26624
s_waitcnt lgkmcnt(10)
v_mfma_f32_16x16x32_bf16 a[64:67], a[128:131], v[144:147], a[64:67]
ds_read_b64_tr_b16 a[152:153], v60 offset:32768
v_and_b32 v24, 1, v0
v_mfma_f32_16x16x32_bf16 a[68:71], a[128:131], v[148:151], a[68:71]
s_waitcnt lgkmcnt(9)
ds_read_b64_tr_b16 a[154:155], v60 offset:34816
v_bfe_u32 v25, v0, 1, 2
v_mfma_f32_16x16x32_bf16 a[68:71], a[132:135], v[156:159], a[68:71]
ds_read_b64_tr_b16 a[156:157], v60 offset:40960
v_lshl_add_u32 v24, v25, 3, v24
v_mfma_f32_16x16x32_bf16 a[64:67], a[132:135], v[152:155], a[64:67]
s_waitcnt lgkmcnt(9)
ds_read_b64_tr_b16 a[158:159], v60 offset:43008
v_bfe_u32 v25, v0, 3, 1
v_mfma_f32_16x16x32_bf16 a[64:67], a[136:139], v[160:163], a[64:67]
ds_read_b64_tr_b16 a[160:161], v7 offset:49152
v_lshl_add_u32 v24, v25, 1, v24
v_mfma_f32_16x16x32_bf16 a[68:71], a[136:139], v[164:167], a[68:71]
s_waitcnt lgkmcnt(9)
ds_read_b64_tr_b16 a[162:163], v7 offset:51200
v_lshlrev_b32 v24, 9, v24
v_mfma_f32_16x16x32_bf16 a[68:71], a[140:143], v[172:175], a[68:71]
ds_read_b64_tr_b16 a[164:165], v7 offset:57344
v_lshrrev_b32 v25, 4, v0
v_mfma_f32_16x16x32_bf16 a[64:67], a[140:143], v[168:171], a[64:67]
s_waitcnt lgkmcnt(9)
ds_read_b64_tr_b16 a[166:167], v7 offset:59392
v_lshl_add_u32 v24, v25, 4, v24
v_mfma_f32_16x16x32_bf16 a[64:67], a[144:147], v[176:179], a[64:67]
ds_read_b64_tr_b16 a[168:169], v61 offset:0
v_mfma_f32_16x16x32_bf16 a[68:71], a[144:147], v[180:183], a[68:71]
s_waitcnt lgkmcnt(9)
ds_read_b64_tr_b16 a[170:171], v61 offset:2048
v_mfma_f32_16x16x32_bf16 a[68:71], a[148:151], v[188:191], a[68:71]
ds_read_b64_tr_b16 a[172:173], v61 offset:8192
v_mfma_f32_16x16x32_bf16 a[64:67], a[148:151], v[184:187], a[64:67]
s_waitcnt lgkmcnt(9)
ds_read_b64_tr_b16 a[174:175], v61 offset:10240
v_mfma_f32_16x16x32_bf16 a[64:67], a[152:155], v[192:195], a[64:67]
ds_read_b64_tr_b16 a[176:177], v61 offset:16384
v_mfma_f32_16x16x32_bf16 a[68:71], a[152:155], v[196:199], a[68:71]
s_waitcnt lgkmcnt(9)
ds_read_b64_tr_b16 a[178:179], v61 offset:18432
v_mfma_f32_16x16x32_bf16 a[68:71], a[156:159], v[44:47], a[68:71]
ds_read_b64_tr_b16 a[180:181], v61 offset:24576
v_mfma_f32_16x16x32_bf16 a[64:67], a[156:159], v[40:43], a[64:67]
s_waitcnt lgkmcnt(9)
ds_read_b64_tr_b16 a[182:183], v61 offset:26624
v_mfma_f32_16x16x32_bf16 a[72:75], a[160:163], v[144:147], a[72:75]
ds_read_b64_tr_b16 a[184:185], v61 offset:32768
v_mfma_f32_16x16x32_bf16 a[76:79], a[160:163], v[148:151], a[76:79]
s_waitcnt lgkmcnt(9)
ds_read_b64_tr_b16 a[186:187], v61 offset:34816
v_mfma_f32_16x16x32_bf16 a[76:79], a[164:167], v[156:159], a[76:79]
ds_read_b64_tr_b16 a[188:189], v61 offset:40960
v_mfma_f32_16x16x32_bf16 a[72:75], a[164:167], v[152:155], a[72:75]
s_waitcnt lgkmcnt(9)
ds_read_b64_tr_b16 a[190:191], v61 offset:43008
v_accvgpr_read_b32 v80, a64
v_mfma_f32_16x16x32_bf16 a[72:75], a[168:171], v[160:163], a[72:75]
ds_read_b64_tr_b16 a[128:129], v8 offset:49152
v_accvgpr_read_b32 v81, a65
v_mfma_f32_16x16x32_bf16 a[76:79], a[168:171], v[164:167], a[76:79]
s_waitcnt lgkmcnt(9)
ds_read_b64_tr_b16 a[130:131], v8 offset:51200
v_accvgpr_read_b32 v82, a66
v_mfma_f32_16x16x32_bf16 a[76:79], a[172:175], v[172:175], a[76:79]
ds_read_b64_tr_b16 a[132:133], v8 offset:57344
v_accvgpr_read_b32 v83, a67
v_mfma_f32_16x16x32_bf16 a[72:75], a[172:175], v[168:171], a[72:75]
s_waitcnt lgkmcnt(9)
ds_read_b64_tr_b16 a[134:135], v8 offset:59392
v_accvgpr_read_b32 v84, a68
v_mfma_f32_16x16x32_bf16 a[72:75], a[176:179], v[176:179], a[72:75]
ds_read_b64_tr_b16 a[136:137], v62 offset:0
v_accvgpr_read_b32 v85, a69
v_mfma_f32_16x16x32_bf16 a[76:79], a[176:179], v[180:183], a[76:79]
s_waitcnt lgkmcnt(9)
ds_read_b64_tr_b16 a[138:139], v62 offset:2048
v_accvgpr_read_b32 v86, a70
v_mfma_f32_16x16x32_bf16 a[76:79], a[180:183], v[188:191], a[76:79]
ds_read_b64_tr_b16 a[140:141], v62 offset:8192
v_accvgpr_read_b32 v87, a71
v_mfma_f32_16x16x32_bf16 a[72:75], a[180:183], v[184:187], a[72:75]
s_waitcnt lgkmcnt(9)
ds_read_b64_tr_b16 a[142:143], v62 offset:10240
v_mfma_f32_16x16x32_bf16 a[72:75], a[184:187], v[192:195], a[72:75]
ds_read_b64_tr_b16 a[144:145], v62 offset:16384
v_mfma_f32_16x16x32_bf16 a[76:79], a[184:187], v[196:199], a[76:79]
s_waitcnt lgkmcnt(9)
ds_read_b64_tr_b16 a[146:147], v62 offset:18432
v_mfma_f32_16x16x32_bf16 a[76:79], a[188:191], v[44:47], a[76:79]
ds_read_b64_tr_b16 a[148:149], v62 offset:24576
v_mfma_f32_16x16x32_bf16 a[72:75], a[188:191], v[40:43], a[72:75]
s_waitcnt lgkmcnt(9)
ds_read_b64_tr_b16 a[150:151], v62 offset:26624
v_mfma_f32_16x16x32_bf16 a[80:83], a[128:131], v[144:147], a[80:83]
ds_read_b64_tr_b16 a[152:153], v62 offset:32768
v_mfma_f32_16x16x32_bf16 a[84:87], a[128:131], v[148:151], a[84:87]
s_waitcnt lgkmcnt(9)
ds_read_b64_tr_b16 a[154:155], v62 offset:34816
v_mfma_f32_16x16x32_bf16 a[84:87], a[132:135], v[156:159], a[84:87]
ds_read_b64_tr_b16 a[156:157], v62 offset:40960
v_mfma_f32_16x16x32_bf16 a[80:83], a[132:135], v[152:155], a[80:83]
s_waitcnt lgkmcnt(9)
ds_read_b64_tr_b16 a[158:159], v62 offset:43008
v_accvgpr_read_b32 v88, a72
v_mfma_f32_16x16x32_bf16 a[80:83], a[136:139], v[160:163], a[80:83]
ds_read_b64_tr_b16 a[160:161], v9 offset:49152
v_accvgpr_read_b32 v89, a73
v_mfma_f32_16x16x32_bf16 a[84:87], a[136:139], v[164:167], a[84:87]
s_waitcnt lgkmcnt(9)
ds_read_b64_tr_b16 a[162:163], v9 offset:51200
v_accvgpr_read_b32 v90, a74
v_mfma_f32_16x16x32_bf16 a[84:87], a[140:143], v[172:175], a[84:87]
ds_read_b64_tr_b16 a[164:165], v9 offset:57344
v_accvgpr_read_b32 v91, a75
v_mfma_f32_16x16x32_bf16 a[80:83], a[140:143], v[168:171], a[80:83]
s_waitcnt lgkmcnt(9)
ds_read_b64_tr_b16 a[166:167], v9 offset:59392
v_accvgpr_read_b32 v92, a76
v_mfma_f32_16x16x32_bf16 a[80:83], a[144:147], v[176:179], a[80:83]
ds_read_b64_tr_b16 a[168:169], v63 offset:0
v_accvgpr_read_b32 v93, a77
v_mfma_f32_16x16x32_bf16 a[84:87], a[144:147], v[180:183], a[84:87]
s_waitcnt lgkmcnt(9)
ds_read_b64_tr_b16 a[170:171], v63 offset:2048
v_accvgpr_read_b32 v94, a78
v_mfma_f32_16x16x32_bf16 a[84:87], a[148:151], v[188:191], a[84:87]
ds_read_b64_tr_b16 a[172:173], v63 offset:8192
v_accvgpr_read_b32 v95, a79
v_mfma_f32_16x16x32_bf16 a[80:83], a[148:151], v[184:187], a[80:83]
s_waitcnt lgkmcnt(9)
ds_read_b64_tr_b16 a[174:175], v63 offset:10240
v_mfma_f32_16x16x32_bf16 a[80:83], a[152:155], v[192:195], a[80:83]
ds_read_b64_tr_b16 a[176:177], v63 offset:16384
v_mfma_f32_16x16x32_bf16 a[84:87], a[152:155], v[196:199], a[84:87]
s_waitcnt lgkmcnt(9)
ds_read_b64_tr_b16 a[178:179], v63 offset:18432
v_mfma_f32_16x16x32_bf16 a[84:87], a[156:159], v[44:47], a[84:87]
ds_read_b64_tr_b16 a[180:181], v63 offset:24576
v_mfma_f32_16x16x32_bf16 a[80:83], a[156:159], v[40:43], a[80:83]
s_waitcnt lgkmcnt(9)
ds_read_b64_tr_b16 a[182:183], v63 offset:26624
v_mfma_f32_16x16x32_bf16 a[88:91], a[160:163], v[144:147], a[88:91]
ds_read_b64_tr_b16 a[184:185], v63 offset:32768
v_mfma_f32_16x16x32_bf16 a[92:95], a[160:163], v[148:151], a[92:95]
s_waitcnt lgkmcnt(9)
ds_read_b64_tr_b16 a[186:187], v63 offset:34816
v_mfma_f32_16x16x32_bf16 a[92:95], a[164:167], v[156:159], a[92:95]
ds_read_b64_tr_b16 a[188:189], v63 offset:40960
v_mfma_f32_16x16x32_bf16 a[88:91], a[164:167], v[152:155], a[88:91]
s_waitcnt lgkmcnt(9)
ds_read_b64_tr_b16 a[190:191], v63 offset:43008
v_accvgpr_read_b32 v96, a80
v_mfma_f32_16x16x32_bf16 a[88:91], a[168:171], v[160:163], a[88:91]
ds_read_b64_tr_b16 a[128:129], v6 offset:53248
v_accvgpr_read_b32 v97, a81
v_mfma_f32_16x16x32_bf16 a[92:95], a[168:171], v[164:167], a[92:95]
s_waitcnt lgkmcnt(9)
ds_read_b64_tr_b16 a[130:131], v6 offset:55296
v_accvgpr_read_b32 v98, a82
v_mfma_f32_16x16x32_bf16 a[92:95], a[172:175], v[172:175], a[92:95]
ds_read_b64_tr_b16 a[132:133], v6 offset:61440
v_accvgpr_read_b32 v99, a83
v_mfma_f32_16x16x32_bf16 a[88:91], a[172:175], v[168:171], a[88:91]
s_waitcnt lgkmcnt(9)
ds_read_b64_tr_b16 a[134:135], v6 offset:63488
v_accvgpr_read_b32 v100, a84
v_mfma_f32_16x16x32_bf16 a[88:91], a[176:179], v[176:179], a[88:91]
ds_read_b64_tr_b16 a[136:137], v60 offset:4096
v_accvgpr_read_b32 v101, a85
v_mfma_f32_16x16x32_bf16 a[92:95], a[176:179], v[180:183], a[92:95]
s_waitcnt lgkmcnt(9)
ds_read_b64_tr_b16 a[138:139], v60 offset:6144
v_accvgpr_read_b32 v102, a86
v_mfma_f32_16x16x32_bf16 a[92:95], a[180:183], v[188:191], a[92:95]
ds_read_b64_tr_b16 a[140:141], v60 offset:12288
v_accvgpr_read_b32 v103, a87
v_mfma_f32_16x16x32_bf16 a[88:91], a[180:183], v[184:187], a[88:91]
s_waitcnt lgkmcnt(9)
ds_read_b64_tr_b16 a[142:143], v60 offset:14336
v_mfma_f32_16x16x32_bf16 a[88:91], a[184:187], v[192:195], a[88:91]
s_waitcnt vmcnt(0)
s_barrier
s_cmp_lg_u32 s40, 0
s_cbranch_scc1 L_noflag2
s_and_b32 s53, s41, 3
s_lshl_b32 s53, s53, 7
s_cmp_eq_u32 s69, 0
s_cselect_b32 s69, s54, s69
v_mov_b32 v16, s53
v_mov_b32 v17, s69
buffer_store_dword v17, v16, s[56:59], 0 offen sc1
v_xor_b32 v16, 256, v16
L_noflag2:
ds_read_b64_tr_b16 a[144:145], v60 offset:20480
v_mfma_f32_16x16x32_bf16 a[92:95], a[184:187], v[196:199], a[92:95]
s_waitcnt lgkmcnt(9)
ds_read_b64_tr_b16 a[146:147], v60 offset:22528
v_mfma_f32_16x16x32_bf16 a[92:95], a[188:191], v[44:47], a[92:95]
ds_read_b64_tr_b16 a[148:149], v60 offset:28672
v_mfma_f32_16x16x32_bf16 a[88:91], a[188:191], v[40:43], a[88:91]
s_waitcnt lgkmcnt(9)
ds_read_b64_tr_b16 a[150:151], v60 offset:30720
v_mfma_f32_16x16x32_bf16 a[96:99], a[128:131], v[144:147], a[96:99]
ds_read_b64_tr_b16 a[152:153], v60 offset:36864
v_mfma_f32_16x16x32_bf16 a[100:103], a[128:131], v[148:151], a[100:103]
s_waitcnt lgkmcnt(9)
ds_read_b64_tr_b16 a[154:155], v60 offset:38912
v_mfma_f32_16x16x32_bf16 a[100:103], a[132:135], v[156:159], a[100:103]
ds_read_b64_tr_b16 a[156:157], v60 offset:45056
v_mfma_f32_16x16x32_bf16 a[96:99], a[132:135], v[152:155], a[96:99]
s_waitcnt lgkmcnt(9)
ds_read_b64_tr_b16 a[158:159], v60 offset:47104
v_accvgpr_read_b32 v104, a88
v_mfma_f32_16x16x32_bf16 a[96:99], a[136:139], v[160:163], a[96:99]
ds_read_b64_tr_b16 a[160:161], v7 offset:53248
v_accvgpr_read_b32 v105, a89
v_mfma_f32_16x16x32_bf16 a[100:103], a[136:139], v[164:167], a[100:103]
s_waitcnt lgkmcnt(9)
ds_read_b64_tr_b16 a[162:163], v7 offset:55296
v_accvgpr_read_b32 v106, a90
v_mfma_f32_16x16x32_bf16 a[100:103], a[140:143], v[172:175], a[100:103]
ds_read_b64_tr_b16 a[164:165], v7 offset:61440
v_accvgpr_read_b32 v107, a91
v_mfma_f32_16x16x32_bf16 a[96:99], a[140:143], v[168:171], a[96:99]
s_waitcnt lgkmcnt(9)
ds_read_b64_tr_b16 a[166:167], v7 offset:63488
v_accvgpr_read_b32 v108, a92
v_mfma_f32_16x16x32_bf16 a[96:99], a[144:147], v[176:179], a[96:99]
ds_read_b64_tr_b16 a[168:169], v61 offset:4096
v_accvgpr_read_b32 v109, a93
v_mfma_f32_16x16x32_bf16 a[100:103], a[144:147], v[180:183], a[100:103]
s_waitcnt lgkmcnt(9)
ds_read_b64_tr_b16 a[170:171], v61 offset:6144
v_accvgpr_read_b32 v110, a94
v_mfma_f32_16x16x32_bf16 a[100:103], a[148:151], v[188:191], a[100:103]
ds_read_b64_tr_b16 a[172:173], v61 offset:12288
v_accvgpr_read_b32 v111, a95
v_mfma_f32_16x16x32_bf16 a[96:99], a[148:151], v[184:187], a[96:99]
s_waitcnt lgkmcnt(9)
ds_read_b64_tr_b16 a[174:175], v61 offset:14336
v_mfma_f32_16x16x32_bf16 a[96:99], a[152:155], v[192:195], a[96:99]
ds_read_b64_tr_b16 a[176:177], v61 offset:20480
v_mfma_f32_16x16x32_bf16 a[100:103], a[152:155], v[196:199], a[100:103]
s_waitcnt lgkmcnt(9)
ds_read_b64_tr_b16 a[178:179], v61 offset:22528
v_mfma_f32_16x16x32_bf16 a[100:103], a[156:159], v[44:47], a[100:103]
ds_read_b64_tr_b16 a[180:181], v61 offset:28672
v_mfma_f32_16x16x32_bf16 a[96:99], a[156:159], v[40:43], a[96:99]
s_waitcnt lgkmcnt(9)
ds_read_b64_tr_b16 a[182:183], v61 offset:30720
v_mfma_f32_16x16x32_bf16 a[104:107], a[160:163], v[144:147], a[104:107]
ds_read_b64_tr_b16 a[184:185], v61 offset:36864
v_mfma_f32_16x16x32_bf16 a[108:111], a[160:163], v[148:151], a[108:111]
s_waitcnt lgkmcnt(9)
ds_read_b64_tr_b16 a[186:187], v61 offset:38912
v_mfma_f32_16x16x32_bf16 a[108:111], a[164:167], v[156:159], a[108:111]
ds_read_b64_tr_b16 a[188:189], v61 offset:45056
v_mfma_f32_16x16x32_bf16 a[104:107], a[164:167], v[152:155], a[104:107]
s_waitcnt lgkmcnt(9)
ds_read_b64_tr_b16 a[190:191], v61 offset:47104
v_accvgpr_read_b32 v112, a96
v_mfma_f32_16x16x32_bf16 a[104:107], a[168:171], v[160:163], a[104:107]
ds_read_b64_tr_b16 a[128:129], v8 offset:53248
v_accvgpr_read_b32 v113, a97
v_mfma_f32_16x16x32_bf16 a[108:111], a[168:171], v[164:167], a[108:111]
s_waitcnt lgkmcnt(9)
ds_read_b64_tr_b16 a[130:131], v8 offset:55296
v_accvgpr_read_b32 v114, a98
v_mfma_f32_16x16x32_bf16 a[108:111], a[172:175], v[172:175], a[108:111]
ds_read_b64_tr_b16 a[132:133], v8 offset:61440
v_accvgpr_read_b32 v115, a99
v_mfma_f32_16x16x32_bf16 a[104:107], a[172:175], v[168:171], a[104:107]
s_waitcnt lgkmcnt(9)
ds_read_b64_tr_b16 a[134:135], v8 offset:63488
v_accvgpr_read_b32 v116, a100
v_mfma_f32_16x16x32_bf16 a[104:107], a[176:179], v[176:179], a[104:107]
ds_read_b64_tr_b16 a[136:137], v62 offset:4096
v_accvgpr_read_b32 v117, a101
v_mfma_f32_16x16x32_bf16 a[108:111], a[176:179], v[180:183], a[108:111]
s_waitcnt lgkmcnt(9)
ds_read_b64_tr_b16 a[138:139], v62 offset:6144
v_accvgpr_read_b32 v118, a102
v_mfma_f32_16x16x32_bf16 a[108:111], a[180:183], v[188:191], a[108:111]
ds_read_b64_tr_b16 a[140:141], v62 offset:12288
v_accvgpr_read_b32 v119, a103
v_mfma_f32_16x16x32_bf16 a[104:107], a[180:183], v[184:187], a[104:107]
s_waitcnt lgkmcnt(9)
ds_read_b64_tr_b16 a[142:143], v62 offset:14336
v_mfma_f32_16x16x32_bf16 a[104:107], a[184:187], v[192:195], a[104:107]
ds_read_b64_tr_b16 a[144:145], v62 offset:20480
v_mfma_f32_16x16x32_bf16 a[108:111], a[184:187], v[196:199], a[108:111]
s_waitcnt lgkmcnt(9)
ds_read_b64_tr_b16 a[146:147], v62 offset:22528
v_mfma_f32_16x16x32_bf16 a[108:111], a[188:191], v[44:47], a[108:111]
ds_read_b64_tr_b16 a[148:149], v62 offset:28672
v_mfma_f32_16x16x32_bf16 a[104:107], a[188:191], v[40:43], a[104:107]
s_waitcnt lgkmcnt(9)
ds_read_b64_tr_b16 a[150:151], v62 offset:30720
v_mfma_f32_16x16x32_bf16 a[112:115], a[128:131], v[144:147], a[112:115]
ds_read_b64_tr_b16 a[152:153], v62 offset:36864
v_mfma_f32_16x16x32_bf16 a[116:119], a[128:131], v[148:151], a[116:119]
s_waitcnt lgkmcnt(9)
ds_read_b64_tr_b16 a[154:155], v62 offset:38912
v_mfma_f32_16x16x32_bf16 a[116:119], a[132:135], v[156:159], a[116:119]
s_cmp_lg_u32 s40, 0
s_cbranch_scc1 L_nopoll
s_mov_b32 s49, 0x400000
L_poll:
buffer_load_dword v18, v16, s[56:59], 0 offen sc1
s_sub_u32 s49, s49, 1
s_cbranch_scc1 L_nopoll
s_waitcnt vmcnt(0)
v_cmp_ne_u32 vcc, s69, v18
s_cbranch_vccnz L_poll
L_nopoll:
s_mov_b32 s53, 0x2000
s_barrier
buffer_load_dwordx4 v[20:23], v50, s[36:39], s53 offen sc1
buffer_load_dwordx4 v[224:227], v48, s[36:39], 0 offen offset:0 sc1
buffer_load_dwordx4 v[228:231], v48, s[36:39], 0 offen offset:1024 sc1
buffer_load_dwordx4 v[232:235], v48, s[36:39], 0 offen offset:2048 sc1
buffer_load_dwordx4 v[236:239], v48, s[36:39], 0 offen offset:3072 sc1
buffer_load_dwordx4 v[240:243], v48, s[36:39], s67 offen offset:0 sc1
buffer_load_dwordx4 v[244:247], v48, s[36:39], s67 offen offset:1024 sc1
buffer_load_dwordx4 v[248:251], v48, s[36:39], s67 offen offset:2048 sc1
buffer_load_dwordx4 v[252:255], v48, s[36:39], s67 offen offset:3072 sc1
ds_read_b64_tr_b16 a[156:157], v62 offset:45056
v_mfma_f32_16x16x32_bf16 a[112:115], a[132:135], v[152:155], a[112:115]
s_waitcnt lgkmcnt(9)
ds_read_b64_tr_b16 a[158:159], v62 offset:47104
v_accvgpr_read_b32 v120, a104
v_mfma_f32_16x16x32_bf16 a[112:115], a[136:139], v[160:163], a[112:115]
ds_read_b64_tr_b16 a[160:161], v9 offset:53248
v_accvgpr_read_b32 v121, a105
v_mfma_f32_16x16x32_bf16 a[116:119], a[136:139], v[164:167], a[116:119]
s_waitcnt lgkmcnt(9)
ds_read_b64_tr_b16 a[162:163], v9 offset:55296
v_accvgpr_read_b32 v122, a106
v_accvgpr_read_b32 v123, a107
v_mfma_f32_16x16x32_bf16 a[116:119], a[140:143], v[172:175], a[116:119]
ds_read_b64_tr_b16 a[164:165], v9 offset:61440
v_accvgpr_read_b32 v124, a108
v_mfma_f32_16x16x32_bf16 a[112:115], a[140:143], v[168:171], a[112:115]
s_waitcnt lgkmcnt(9)
ds_read_b64_tr_b16 a[166:167], v9 offset:63488
v_accvgpr_read_b32 v125, a109
v_mfma_f32_16x16x32_bf16 a[112:115], a[144:147], v[176:179], a[112:115]
ds_read_b64_tr_b16 a[168:169], v63 offset:4096
v_accvgpr_read_b32 v126, a110
v_mfma_f32_16x16x32_bf16 a[116:119], a[144:147], v[180:183], a[116:119]
s_waitcnt lgkmcnt(9)
ds_read_b64_tr_b16 a[170:171], v63 offset:6144
v_accvgpr_read_b32 v127, a111
v_mfma_f32_16x16x32_bf16 a[116:119], a[148:151], v[188:191], a[116:119]
ds_read_b64_tr_b16 a[172:173], v63 offset:12288
v_mfma_f32_16x16x32_bf16 a[112:115], a[148:151], v[184:187], a[112:115]
s_waitcnt lgkmcnt(9)
ds_read_b64_tr_b16 a[174:175], v63 offset:14336
v_mfma_f32_16x16x32_bf16 a[112:115], a[152:155], v[192:195], a[112:115]
ds_read_b64_tr_b16 a[176:177], v63 offset:20480
v_mfma_f32_16x16x32_bf16 a[116:119], a[152:155], v[196:199], a[116:119]
s_waitcnt lgkmcnt(9)
ds_read_b64_tr_b16 a[178:179], v63 offset:22528
v_mfma_f32_16x16x32_bf16 a[116:119], a[156:159], v[44:47], a[116:119]
ds_read_b64_tr_b16 a[180:181], v63 offset:28672
v_mfma_f32_16x16x32_bf16 a[112:115], a[156:159], v[40:43], a[112:115]
s_waitcnt lgkmcnt(9)
ds_read_b64_tr_b16 a[182:183], v63 offset:30720
v_mfma_f32_16x16x32_bf16 a[120:123], a[160:163], v[144:147], a[120:123]
ds_read_b64_tr_b16 a[184:185], v63 offset:36864
v_mfma_f32_16x16x32_bf16 a[124:127], a[160:163], v[148:151], a[124:127]
s_waitcnt lgkmcnt(9)
ds_read_b64_tr_b16 a[186:187], v63 offset:38912
v_mfma_f32_16x16x32_bf16 a[124:127], a[164:167], v[156:159], a[124:127]
ds_read_b64_tr_b16 a[188:189], v63 offset:45056
v_mfma_f32_16x16x32_bf16 a[120:123], a[164:167], v[152:155], a[120:123]
s_waitcnt lgkmcnt(9)
ds_read_b64_tr_b16 a[190:191], v63 offset:47104
v_accvgpr_read_b32 v128, a112
v_accvgpr_read_b32 v129, a113
v_mfma_f32_16x16x32_bf16 a[120:123], a[168:171], v[160:163], a[120:123]
v_accvgpr_read_b32 v130, a114
v_accvgpr_read_b32 v131, a115
v_mfma_f32_16x16x32_bf16 a[124:127], a[168:171], v[164:167], a[124:127]
s_waitcnt lgkmcnt(8)
v_accvgpr_read_b32 v132, a116
v_mfma_f32_16x16x32_bf16 a[124:127], a[172:175], v[172:175], a[124:127]
v_accvgpr_read_b32 v133, a117
v_mfma_f32_16x16x32_bf16 a[120:123], a[172:175], v[168:171], a[120:123]
s_waitcnt lgkmcnt(6)
v_accvgpr_read_b32 v134, a118
v_mfma_f32_16x16x32_bf16 a[120:123], a[176:179], v[176:179], a[120:123]
v_accvgpr_read_b32 v135, a119
v_mfma_f32_16x16x32_bf16 a[124:127], a[176:179], v[180:183], a[124:127]
s_waitcnt lgkmcnt(4)
v_mfma_f32_16x16x32_bf16 a[124:127], a[180:183], v[188:191], a[124:127]
v_mfma_f32_16x16x32_bf16 a[120:123], a[180:183], v[184:187], a[120:123]
s_waitcnt lgkmcnt(2)
v_mfma_f32_16x16x32_bf16 a[120:123], a[184:187], v[192:195], a[120:123]
v_mfma_f32_16x16x32_bf16 a[124:127], a[184:187], v[196:199], a[124:127]
s_waitcnt lgkmcnt(0)
v_mfma_f32_16x16x32_bf16 a[124:127], a[188:191], v[44:47], a[124:127]
v_mfma_f32_16x16x32_bf16 a[120:123], a[188:191], v[40:43], a[120:123]
s_lshl_b32 s53, s40, 14
s_lshl_b32 s52, s44, 8
s_add_u32 s53, s53, s52
s_nop 4
v_accvgpr_read_b32 v136, a120
v_accvgpr_read_b32 v137, a121
v_accvgpr_read_b32 v138, a122
v_accvgpr_read_b32 v139, a123
v_accvgpr_read_b32 v140, a124
v_accvgpr_read_b32 v141, a125
v_accvgpr_read_b32 v142, a126
v_accvgpr_read_b32 v143, a127
s_waitcnt vmcnt(8)
v_max_f32 v18, v56, v20
v_sub_f32 v26, v56, v18
v_sub_f32 v30, v20, v18
v_exp_f32 v26, v26
v_exp_f32 v30, v30
s_nop 0
v_mul_f32 v18, v26, v58
v_fmac_f32 v18, v30, v22
v_rcp_f32 v18, v18
s_nop 0
v_mul_f32 v26, v26, v18
v_mul_f32 v30, v30, v18
v_max_f32 v18, v57, v21
v_sub_f32 v28, v57, v18
v_sub_f32 v16, v21, v18
v_exp_f32 v28, v28
v_exp_f32 v16, v16
s_nop 0
v_mul_f32 v18, v28, v59
v_fmac_f32 v18, v16, v23
v_rcp_f32 v18, v18
s_nop 0
v_mul_f32 v28, v28, v18
v_mul_f32 v16, v16, v18
s_waitcnt vmcnt(6)
v_lshlrev_b32 v32, 16, v224
v_and_b32 v33, 0xffff0000, v224
v_lshlrev_b32 v34, 16, v225
v_and_b32 v35, 0xffff0000, v225
v_pk_mul_f32 v[80:81], v[80:81], v[26:27] op_sel_hi:[1,0]
v_pk_mul_f32 v[82:83], v[82:83], v[26:27] op_sel_hi:[1,0]
v_pk_fma_f32 v[80:81], v[32:33], v[30:31], v[80:81] op_sel_hi:[1,0,1]
v_pk_fma_f32 v[82:83], v[34:35], v[30:31], v[82:83] op_sel_hi:[1,0,1]
v_cvt_pk_bf16_f32 v64, v80, v81
v_cvt_pk_bf16_f32 v65, v82, v83
v_lshlrev_b32 v36, 16, v228
v_and_b32 v37, 0xffff0000, v228
v_lshlrev_b32 v38, 16, v229
v_and_b32 v39, 0xffff0000, v229
v_pk_mul_f32 v[88:89], v[88:89], v[26:27] op_sel_hi:[1,0]
v_pk_mul_f32 v[90:91], v[90:91], v[26:27] op_sel_hi:[1,0]
v_pk_fma_f32 v[88:89], v[36:37], v[30:31], v[88:89] op_sel_hi:[1,0,1]
v_pk_fma_f32 v[90:91], v[38:39], v[30:31], v[90:91] op_sel_hi:[1,0,1]
v_cvt_pk_bf16_f32 v66, v88, v89
v_cvt_pk_bf16_f32 v67, v90, v91
s_nop 1
v_permlane32_swap_b32 v64, v66
v_permlane32_swap_b32 v65, v67
s_nop 0
v_permlane16_swap_b32 v64, v66
v_permlane16_swap_b32 v65, v67
buffer_store_dwordx4 v[64:67], v24, s[28:31], s53 offen offset:0 sc1
v_lshlrev_b32 v32, 16, v226
v_and_b32 v33, 0xffff0000, v226
v_lshlrev_b32 v34, 16, v227
v_and_b32 v35, 0xffff0000, v227
v_pk_mul_f32 v[84:85], v[84:85], v[28:29] op_sel_hi:[1,0]
v_pk_mul_f32 v[86:87], v[86:87], v[28:29] op_sel_hi:[1,0]
v_pk_fma_f32 v[84:85], v[32:33], v[16:17], v[84:85] op_sel_hi:[1,0,1]
v_pk_fma_f32 v[86:87], v[34:35], v[16:17], v[86:87] op_sel_hi:[1,0,1]
v_cvt_pk_bf16_f32 v68, v84, v85
v_cvt_pk_bf16_f32 v69, v86, v87
v_lshlrev_b32 v36, 16, v230
v_and_b32 v37, 0xffff0000, v230
v_lshlrev_b32 v38, 16, v231
v_and_b32 v39, 0xffff0000, v231
v_pk_mul_f32 v[92:93], v[92:93], v[28:29] op_sel_hi:[1,0]
v_pk_mul_f32 v[94:95], v[94:95], v[28:29] op_sel_hi:[1,0]
v_pk_fma_f32 v[92:93], v[36:37], v[16:17], v[92:93] op_sel_hi:[1,0,1]
v_pk_fma_f32 v[94:95], v[38:39], v[16:17], v[94:95] op_sel_hi:[1,0,1]
v_cvt_pk_bf16_f32 v70, v92, v93
v_cvt_pk_bf16_f32 v71, v94, v95
s_nop 1
v_permlane32_swap_b32 v68, v70
v_permlane32_swap_b32 v69, v71
s_nop 0
v_permlane16_swap_b32 v68, v70
v_permlane16_swap_b32 v69, v71
buffer_store_dwordx4 v[68:71], v24, s[28:31], s53 offen offset:2048 sc1
s_waitcnt vmcnt(6)
v_lshlrev_b32 v32, 16, v232
v_and_b32 v33, 0xffff0000, v232
v_lshlrev_b32 v34, 16, v233
v_and_b32 v35, 0xffff0000, v233
v_pk_mul_f32 v[96:97], v[96:97], v[26:27] op_sel_hi:[1,0]
v_pk_mul_f32 v[98:99], v[98:99], v[26:27] op_sel_hi:[1,0]
v_pk_fma_f32 v[96:97], v[32:33], v[30:31], v[96:97] op_sel_hi:[1,0,1]
v_pk_fma_f32 v[98:99], v[34:35], v[30:31], v[98:99] op_sel_hi:[1,0,1]
v_cvt_pk_bf16_f32 v72, v96, v97
v_cvt_pk_bf16_f32 v73, v98, v99
v_lshlrev_b32 v36, 16, v236
v_and_b32 v37, 0xffff0000, v236
v_lshlrev_b32 v38, 16, v237
v_and_b32 v39, 0xffff0000, v237
v_pk_mul_f32 v[104:105], v[104:105], v[26:27] op_sel_hi:[1,0]
v_pk_mul_f32 v[106:107], v[106:107], v[26:27] op_sel_hi:[1,0]
v_pk_fma_f32 v[104:105], v[36:37], v[30:31], v[104:105] op_sel_hi:[1,0,1]
v_pk_fma_f32 v[106:107], v[38:39], v[30:31], v[106:107] op_sel_hi:[1,0,1]
v_cvt_pk_bf16_f32 v74, v104, v105
v_cvt_pk_bf16_f32 v75, v106, v107
s_nop 1
v_permlane32_swap_b32 v72, v74
v_permlane32_swap_b32 v73, v75
s_nop 0
v_permlane16_swap_b32 v72, v74
v_permlane16_swap_b32 v73, v75
buffer_store_dwordx4 v[72:75], v24, s[28:31], s53 offen offset:64 sc1
v_lshlrev_b32 v32, 16, v234
v_and_b32 v33, 0xffff0000, v234
v_lshlrev_b32 v34, 16, v235
v_and_b32 v35, 0xffff0000, v235
v_pk_mul_f32 v[100:101], v[100:101], v[28:29] op_sel_hi:[1,0]
v_pk_mul_f32 v[102:103], v[102:103], v[28:29] op_sel_hi:[1,0]
v_pk_fma_f32 v[100:101], v[32:33], v[16:17], v[100:101] op_sel_hi:[1,0,1]
v_pk_fma_f32 v[102:103], v[34:35], v[16:17], v[102:103] op_sel_hi:[1,0,1]
v_cvt_pk_bf16_f32 v76, v100, v101
v_cvt_pk_bf16_f32 v77, v102, v103
v_lshlrev_b32 v36, 16, v238
v_and_b32 v37, 0xffff0000, v238
v_lshlrev_b32 v38, 16, v239
v_and_b32 v39, 0xffff0000, v239
v_pk_mul_f32 v[108:109], v[108:109], v[28:29] op_sel_hi:[1,0]
v_pk_mul_f32 v[110:111], v[110:111], v[28:29] op_sel_hi:[1,0]
v_pk_fma_f32 v[108:109], v[36:37], v[16:17], v[108:109] op_sel_hi:[1,0,1]
v_pk_fma_f32 v[110:111], v[38:39], v[16:17], v[110:111] op_sel_hi:[1,0,1]
v_cvt_pk_bf16_f32 v78, v108, v109
v_cvt_pk_bf16_f32 v79, v110, v111
s_nop 1
v_permlane32_swap_b32 v76, v78
v_permlane32_swap_b32 v77, v79
s_nop 0
v_permlane16_swap_b32 v76, v78
v_permlane16_swap_b32 v77, v79
buffer_store_dwordx4 v[76:79], v24, s[28:31], s53 offen offset:2112 sc1
s_waitcnt vmcnt(6)
v_lshlrev_b32 v32, 16, v240
v_and_b32 v33, 0xffff0000, v240
v_lshlrev_b32 v34, 16, v241
v_and_b32 v35, 0xffff0000, v241
v_pk_mul_f32 v[112:113], v[112:113], v[26:27] op_sel_hi:[1,0]
v_pk_mul_f32 v[114:115], v[114:115], v[26:27] op_sel_hi:[1,0]
v_pk_fma_f32 v[112:113], v[32:33], v[30:31], v[112:113] op_sel_hi:[1,0,1]
v_pk_fma_f32 v[114:115], v[34:35], v[30:31], v[114:115] op_sel_hi:[1,0,1]
v_cvt_pk_bf16_f32 v64, v112, v113
v_cvt_pk_bf16_f32 v65, v114, v115
v_lshlrev_b32 v36, 16, v244
v_and_b32 v37, 0xffff0000, v244
v_lshlrev_b32 v38, 16, v245
v_and_b32 v39, 0xffff0000, v245
v_pk_mul_f32 v[120:121], v[120:121], v[26:27] op_sel_hi:[1,0]
v_pk_mul_f32 v[122:123], v[122:123], v[26:27] op_sel_hi:[1,0]
v_pk_fma_f32 v[120:121], v[36:37], v[30:31], v[120:121] op_sel_hi:[1,0,1]
v_pk_fma_f32 v[122:123], v[38:39], v[30:31], v[122:123] op_sel_hi:[1,0,1]
v_cvt_pk_bf16_f32 v66, v120, v121
v_cvt_pk_bf16_f32 v67, v122, v123
s_nop 1
v_permlane32_swap_b32 v64, v66
v_permlane32_swap_b32 v65, v67
s_nop 0
v_permlane16_swap_b32 v64, v66
v_permlane16_swap_b32 v65, v67
buffer_store_dwordx4 v[64:67], v24, s[28:31], s53 offen offset:128 sc1
v_lshlrev_b32 v32, 16, v242
v_and_b32 v33, 0xffff0000, v242
v_lshlrev_b32 v34, 16, v243
v_and_b32 v35, 0xffff0000, v243
v_pk_mul_f32 v[116:117], v[116:117], v[28:29] op_sel_hi:[1,0]
v_pk_mul_f32 v[118:119], v[118:119], v[28:29] op_sel_hi:[1,0]
v_pk_fma_f32 v[116:117], v[32:33], v[16:17], v[116:117] op_sel_hi:[1,0,1]
v_pk_fma_f32 v[118:119], v[34:35], v[16:17], v[118:119] op_sel_hi:[1,0,1]
v_cvt_pk_bf16_f32 v68, v116, v117
v_cvt_pk_bf16_f32 v69, v118, v119
v_lshlrev_b32 v36, 16, v246
v_and_b32 v37, 0xffff0000, v246
v_lshlrev_b32 v38, 16, v247
v_and_b32 v39, 0xffff0000, v247
v_pk_mul_f32 v[124:125], v[124:125], v[28:29] op_sel_hi:[1,0]
v_pk_mul_f32 v[126:127], v[126:127], v[28:29] op_sel_hi:[1,0]
v_pk_fma_f32 v[124:125], v[36:37], v[16:17], v[124:125] op_sel_hi:[1,0,1]
v_pk_fma_f32 v[126:127], v[38:39], v[16:17], v[126:127] op_sel_hi:[1,0,1]
v_cvt_pk_bf16_f32 v70, v124, v125
v_cvt_pk_bf16_f32 v71, v126, v127
s_nop 1
v_permlane32_swap_b32 v68, v70
v_permlane32_swap_b32 v69, v71
s_nop 0
v_permlane16_swap_b32 v68, v70
v_permlane16_swap_b32 v69, v71
buffer_store_dwordx4 v[68:71], v24, s[28:31], s53 offen offset:2176 sc1
s_waitcnt vmcnt(6)
v_lshlrev_b32 v32, 16, v248
v_and_b32 v33, 0xffff0000, v248
v_lshlrev_b32 v34, 16, v249
v_and_b32 v35, 0xffff0000, v249
v_pk_mul_f32 v[128:129], v[128:129], v[26:27] op_sel_hi:[1,0]
v_pk_mul_f32 v[130:131], v[130:131], v[26:27] op_sel_hi:[1,0]
v_pk_fma_f32 v[128:129], v[32:33], v[30:31], v[128:129] op_sel_hi:[1,0,1]
v_pk_fma_f32 v[130:131], v[34:35], v[30:31], v[130:131] op_sel_hi:[1,0,1]
v_cvt_pk_bf16_f32 v72, v128, v129
v_cvt_pk_bf16_f32 v73, v130, v131
v_lshlrev_b32 v36, 16, v252
v_and_b32 v37, 0xffff0000, v252
v_lshlrev_b32 v38, 16, v253
v_and_b32 v39, 0xffff0000, v253
v_pk_mul_f32 v[136:137], v[136:137], v[26:27] op_sel_hi:[1,0]
v_pk_mul_f32 v[138:139], v[138:139], v[26:27] op_sel_hi:[1,0]
v_pk_fma_f32 v[136:137], v[36:37], v[30:31], v[136:137] op_sel_hi:[1,0,1]
v_pk_fma_f32 v[138:139], v[38:39], v[30:31], v[138:139] op_sel_hi:[1,0,1]
v_cvt_pk_bf16_f32 v74, v136, v137
v_cvt_pk_bf16_f32 v75, v138, v139
s_nop 1
v_permlane32_swap_b32 v72, v74
v_permlane32_swap_b32 v73, v75
s_nop 0
v_permlane16_swap_b32 v72, v74
v_permlane16_swap_b32 v73, v75
buffer_store_dwordx4 v[72:75], v24, s[28:31], s53 offen offset:192 sc1
v_lshlrev_b32 v32, 16, v250
v_and_b32 v33, 0xffff0000, v250
v_lshlrev_b32 v34, 16, v251
v_and_b32 v35, 0xffff0000, v251
v_pk_mul_f32 v[132:133], v[132:133], v[28:29] op_sel_hi:[1,0]
v_pk_mul_f32 v[134:135], v[134:135], v[28:29] op_sel_hi:[1,0]
v_pk_fma_f32 v[132:133], v[32:33], v[16:17], v[132:133] op_sel_hi:[1,0,1]
v_pk_fma_f32 v[134:135], v[34:35], v[16:17], v[134:135] op_sel_hi:[1,0,1]
v_cvt_pk_bf16_f32 v76, v132, v133
v_cvt_pk_bf16_f32 v77, v134, v135
v_lshlrev_b32 v36, 16, v254
v_and_b32 v37, 0xffff0000, v254
v_lshlrev_b32 v38, 16, v255
v_and_b32 v39, 0xffff0000, v255
v_pk_mul_f32 v[140:141], v[140:141], v[28:29] op_sel_hi:[1,0]
v_pk_mul_f32 v[142:143], v[142:143], v[28:29] op_sel_hi:[1,0]
v_pk_fma_f32 v[140:141], v[36:37], v[16:17], v[140:141] op_sel_hi:[1,0,1]
v_pk_fma_f32 v[142:143], v[38:39], v[16:17], v[142:143] op_sel_hi:[1,0,1]
v_cvt_pk_bf16_f32 v78, v140, v141
v_cvt_pk_bf16_f32 v79, v142, v143
s_nop 1
v_permlane32_swap_b32 v76, v78
v_permlane32_swap_b32 v77, v79
s_nop 0
v_permlane16_swap_b32 v76, v78
v_permlane16_swap_b32 v77, v79
buffer_store_dwordx4 v[76:79], v24, s[28:31], s53 offen offset:2240 sc1
L_end:
s_endpgm
L_extra0:
s_mov_b32 m0, s100
s_add_u32 s100, s100, 0x2000
buffer_load_dwordx4 v3, s[20:23], s65 offen offset:0 nt lds
buffer_load_dwordx4 v3, s[20:23], s65 offen offset:1024 nt lds
s_add_u32 s65, s65, 0x4000
s_cmp_ge_u32 s100, s42
s_cbranch_scc1 L_extra0_back
s_mov_b32 m0, s100
s_add_u32 s100, s100, 0x2000
buffer_load_dwordx4 v3, s[20:23], s65 offen offset:0 nt lds
buffer_load_dwordx4 v3, s[20:23], s65 offen offset:1024 nt lds
s_add_u32 s65, s65, 0x4000
s_branch L_extra0_back
L_extra1:
s_mov_b32 m0, s100
s_add_u32 s100, s100, 0x2000
buffer_load_dwordx4 v3, s[20:23], s65 offen offset:0 nt lds
buffer_load_dwordx4 v3, s[20:23], s65 offen offset:1024 nt lds
s_add_u32 s65, s65, 0x4000
s_branch L_extra1_back
L_rare_f:
v_max3_f32 v18, v64, v65, v66
v_max3_f32 v18, v18, v67, v68
v_max3_f32 v18, v18, v69, v70
v_max_f32 v18, v18, v71
v_mov_b32 v19, v18
s_nop 1
v_permlane32_swap_b32 v19, v18
v_max_f32 v18, v18, v19
v_mov_b32 v19, v18
s_nop 1
v_permlane16_swap_b32 v19, v18
v_max_f32 v18, v18, v19
v_ceil_f32 v18, v18
v_max_f32 v18, 0, v18
v_exp_f32 v16, -v18
v_add_f32 v10, v10, v18
v_sub_f32 v248, v248, v18
v_sub_f32 v249, v249, v18
v_sub_f32 v250, v250, v18
v_sub_f32 v251, v251, v18
v_sub_f32 v64, v64, v18
v_sub_f32 v65, v65, v18
v_sub_f32 v66, v66, v18
v_sub_f32 v67, v67, v18
v_sub_f32 v68, v68, v18
v_sub_f32 v69, v69, v18
v_sub_f32 v70, v70, v18
v_sub_f32 v71, v71, v18
v_sub_f32 v48, v48, v18
v_sub_f32 v49, v49, v18
v_sub_f32 v50, v50, v18
v_sub_f32 v51, v51, v18
v_sub_f32 v52, v52, v18
v_sub_f32 v53, v53, v18
v_sub_f32 v54, v54, v18
v_sub_f32 v55, v55, v18
v_mul_f32 v12, v12, v16
v_max3_f32 v18, v72, v73, v74
v_max3_f32 v18, v18, v75, v76
v_max3_f32 v18, v18, v77, v78
v_max_f32 v18, v18, v79
v_mov_b32 v19, v18
s_nop 1
v_permlane32_swap_b32 v19, v18
v_max_f32 v18, v18, v19
v_mov_b32 v19, v18
s_nop 1
v_permlane16_swap_b32 v19, v18
v_max_f32 v18, v18, v19
v_ceil_f32 v18, v18
v_max_f32 v18, 0, v18
v_exp_f32 v17, -v18
v_add_f32 v11, v11, v18
v_sub_f32 v252, v252, v18
v_sub_f32 v253, v253, v18
v_sub_f32 v254, v254, v18
v_sub_f32 v255, v255, v18
v_sub_f32 v72, v72, v18
v_sub_f32 v73, v73, v18
v_sub_f32 v74, v74, v18
v_sub_f32 v75, v75, v18
v_sub_f32 v76, v76, v18
v_sub_f32 v77, v77, v18
v_sub_f32 v78, v78, v18
v_sub_f32 v79, v79, v18
v_sub_f32 v56, v56, v18
v_sub_f32 v57, v57, v18
v_sub_f32 v58, v58, v18
v_sub_f32 v59, v59, v18
v_sub_f32 v60, v60, v18
v_sub_f32 v61, v61, v18
v_sub_f32 v62, v62, v18
v_sub_f32 v63, v63, v18
v_mul_f32 v13, v13, v17
s_nop 7
s_nop 7
v_accvgpr_read_b32 v20, a0
v_accvgpr_read_b32 v21, a1
v_accvgpr_read_b32 v22, a2
v_accvgpr_read_b32 v23, a3
v_mul_f32 v20, v20, v16
v_mul_f32 v21, v21, v16
v_mul_f32 v22, v22, v16
v_mul_f32 v23, v23, v16
v_accvgpr_write_b32 a0, v20
v_accvgpr_write_b32 a1, v21
v_accvgpr_write_b32 a2, v22
v_accvgpr_write_b32 a3, v23
v_accvgpr_read_b32 v20, a4
v_accvgpr_read_b32 v21, a5
v_accvgpr_read_b32 v22, a6
v_accvgpr_read_b32 v23, a7
v_mul_f32 v20, v20, v17
v_mul_f32 v21, v21, v17
v_mul_f32 v22, v22, v17
v_mul_f32 v23, v23, v17
v_accvgpr_write_b32 a4, v20
v_accvgpr_write_b32 a5, v21
v_accvgpr_write_b32 a6, v22
v_accvgpr_write_b32 a7, v23
v_accvgpr_read_b32 v20, a8
v_accvgpr_read_b32 v21, a9
v_accvgpr_read_b32 v22, a10
v_accvgpr_read_b32 v23, a11
v_mul_f32 v20, v20, v16
v_mul_f32 v21, v21, v16
v_mul_f32 v22, v22, v16
v_mul_f32 v23, v23, v16
v_accvgpr_write_b32 a8, v20
v_accvgpr_write_b32 a9, v21
v_accvgpr_write_b32 a10, v22
v_accvgpr_write_b32 a11, v23
v_accvgpr_read_b32 v20, a12
v_accvgpr_read_b32 v21, a13
v_accvgpr_read_b32 v22, a14
v_accvgpr_read_b32 v23, a15
v_mul_f32 v20, v20, v17
v_mul_f32 v21, v21, v17
v_mul_f32 v22, v22, v17
v_mul_f32 v23, v23, v17
v_accvgpr_write_b32 a12, v20
v_accvgpr_write_b32 a13, v21
v_accvgpr_write_b32 a14, v22
v_accvgpr_write_b32 a15, v23
v_accvgpr_read_b32 v20, a16
v_accvgpr_read_b32 v21, a17
v_accvgpr_read_b32 v22, a18
v_accvgpr_read_b32 v23, a19
v_mul_f32 v20, v20, v16
v_mul_f32 v21, v21, v16
v_mul_f32 v22, v22, v16
v_mul_f32 v23, v23, v16
v_accvgpr_write_b32 a16, v20
v_accvgpr_write_b32 a17, v21
v_accvgpr_write_b32 a18, v22
v_accvgpr_write_b32 a19, v23
v_accvgpr_read_b32 v20, a20
v_accvgpr_read_b32 v21, a21
v_accvgpr_read_b32 v22, a22
v_accvgpr_read_b32 v23, a23
v_mul_f32 v20, v20, v17
v_mul_f32 v21, v21, v17
v_mul_f32 v22, v22, v17
v_mul_f32 v23, v23, v17
v_accvgpr_write_b32 a20, v20
v_accvgpr_write_b32 a21, v21
v_accvgpr_write_b32 a22, v22
v_accvgpr_write_b32 a23, v23
v_accvgpr_read_b32 v20, a24
v_accvgpr_read_b32 v21, a25
v_accvgpr_read_b32 v22, a26
v_accvgpr_read_b32 v23, a27
v_mul_f32 v20, v20, v16
v_mul_f32 v21, v21, v16
v_mul_f32 v22, v22, v16
v_mul_f32 v23, v23, v16
v_accvgpr_write_b32 a24, v20
v_accvgpr_write_b32 a25, v21
v_accvgpr_write_b32 a26, v22
v_accvgpr_write_b32 a27, v23
v_accvgpr_read_b32 v20, a28
v_accvgpr_read_b32 v21, a29
v_accvgpr_read_b32 v22, a30
v_accvgpr_read_b32 v23, a31
v_mul_f32 v20, v20, v17
v_mul_f32 v21, v21, v17
v_mul_f32 v22, v22, v17
v_mul_f32 v23, v23, v17
v_accvgpr_write_b32 a28, v20
v_accvgpr_write_b32 a29, v21
v_accvgpr_write_b32 a30, v22
v_accvgpr_write_b32 a31, v23
v_accvgpr_read_b32 v20, a32
v_accvgpr_read_b32 v21, a33
v_accvgpr_read_b32 v22, a34
v_accvgpr_read_b32 v23, a35
v_mul_f32 v20, v20, v16
v_mul_f32 v21, v21, v16
v_mul_f32 v22, v22, v16
v_mul_f32 v23, v23, v16
v_accvgpr_write_b32 a32, v20
v_accvgpr_write_b32 a33, v21
v_accvgpr_write_b32 a34, v22
v_accvgpr_write_b32 a35, v23
v_accvgpr_read_b32 v20, a36
v_accvgpr_read_b32 v21, a37
v_accvgpr_read_b32 v22, a38
v_accvgpr_read_b32 v23, a39
v_mul_f32 v20, v20, v17
v_mul_f32 v21, v21, v17
v_mul_f32 v22, v22, v17
v_mul_f32 v23, v23, v17
v_accvgpr_write_b32 a36, v20
v_accvgpr_write_b32 a37, v21
v_accvgpr_write_b32 a38, v22
v_accvgpr_write_b32 a39, v23
v_accvgpr_read_b32 v20, a40
v_accvgpr_read_b32 v21, a41
v_accvgpr_read_b32 v22, a42
v_accvgpr_read_b32 v23, a43
v_mul_f32 v20, v20, v16
v_mul_f32 v21, v21, v16
v_mul_f32 v22, v22, v16
v_mul_f32 v23, v23, v16
v_accvgpr_write_b32 a40, v20
v_accvgpr_write_b32 a41, v21
v_accvgpr_write_b32 a42, v22
v_accvgpr_write_b32 a43, v23
v_accvgpr_read_b32 v20, a44
v_accvgpr_read_b32 v21, a45
v_accvgpr_read_b32 v22, a46
v_accvgpr_read_b32 v23, a47
v_mul_f32 v20, v20, v17
v_mul_f32 v21, v21, v17
v_mul_f32 v22, v22, v17
v_mul_f32 v23, v23, v17
v_accvgpr_write_b32 a44, v20
v_accvgpr_write_b32 a45, v21
v_accvgpr_write_b32 a46, v22
v_accvgpr_write_b32 a47, v23
v_accvgpr_read_b32 v20, a48
v_accvgpr_read_b32 v21, a49
v_accvgpr_read_b32 v22, a50
v_accvgpr_read_b32 v23, a51
v_mul_f32 v20, v20, v16
v_mul_f32 v21, v21, v16
v_mul_f32 v22, v22, v16
v_mul_f32 v23, v23, v16
v_accvgpr_write_b32 a48, v20
v_accvgpr_write_b32 a49, v21
v_accvgpr_write_b32 a50, v22
v_accvgpr_write_b32 a51, v23
v_accvgpr_read_b32 v20, a52
v_accvgpr_read_b32 v21, a53
v_accvgpr_read_b32 v22, a54
v_accvgpr_read_b32 v23, a55
v_mul_f32 v20, v20, v17
v_mul_f32 v21, v21, v17
v_mul_f32 v22, v22, v17
v_mul_f32 v23, v23, v17
v_accvgpr_write_b32 a52, v20
v_accvgpr_write_b32 a53, v21
v_accvgpr_write_b32 a54, v22
v_accvgpr_write_b32 a55, v23
v_accvgpr_read_b32 v20, a56
v_accvgpr_read_b32 v21, a57
v_accvgpr_read_b32 v22, a58
v_accvgpr_read_b32 v23, a59
v_mul_f32 v20, v20, v16
v_mul_f32 v21, v21, v16
v_mul_f32 v22, v22, v16
v_mul_f32 v23, v23, v16
v_accvgpr_write_b32 a56, v20
v_accvgpr_write_b32 a57, v21
v_accvgpr_write_b32 a58, v22
v_accvgpr_write_b32 a59, v23
v_accvgpr_read_b32 v20, a60
v_accvgpr_read_b32 v21, a61
v_accvgpr_read_b32 v22, a62
v_accvgpr_read_b32 v23, a63
v_mul_f32 v20, v20, v17
v_mul_f32 v21, v21, v17
v_mul_f32 v22, v22, v17
v_mul_f32 v23, v23, v17
v_accvgpr_write_b32 a60, v20
v_accvgpr_write_b32 a61, v21
v_accvgpr_write_b32 a62, v22
v_accvgpr_write_b32 a63, v23
v_accvgpr_read_b32 v20, a64
v_accvgpr_read_b32 v21, a65
v_accvgpr_read_b32 v22, a66
v_accvgpr_read_b32 v23, a67
v_mul_f32 v20, v20, v16
v_mul_f32 v21, v21, v16
v_mul_f32 v22, v22, v16
v_mul_f32 v23, v23, v16
v_accvgpr_write_b32 a64, v20
v_accvgpr_write_b32 a65, v21
v_accvgpr_write_b32 a66, v22
v_accvgpr_write_b32 a67, v23
v_accvgpr_read_b32 v20, a68
v_accvgpr_read_b32 v21, a69
v_accvgpr_read_b32 v22, a70
v_accvgpr_read_b32 v23, a71
v_mul_f32 v20, v20, v17
v_mul_f32 v21, v21, v17
v_mul_f32 v22, v22, v17
v_mul_f32 v23, v23, v17
v_accvgpr_write_b32 a68, v20
v_accvgpr_write_b32 a69, v21
v_accvgpr_write_b32 a70, v22
v_accvgpr_write_b32 a71, v23
v_accvgpr_read_b32 v20, a72
v_accvgpr_read_b32 v21, a73
v_accvgpr_read_b32 v22, a74
v_accvgpr_read_b32 v23, a75
v_mul_f32 v20, v20, v16
v_mul_f32 v21, v21, v16
v_mul_f32 v22, v22, v16
v_mul_f32 v23, v23, v16
v_accvgpr_write_b32 a72, v20
v_accvgpr_write_b32 a73, v21
v_accvgpr_write_b32 a74, v22
v_accvgpr_write_b32 a75, v23
v_accvgpr_read_b32 v20, a76
v_accvgpr_read_b32 v21, a77
v_accvgpr_read_b32 v22, a78
v_accvgpr_read_b32 v23, a79
v_mul_f32 v20, v20, v17
v_mul_f32 v21, v21, v17
v_mul_f32 v22, v22, v17
v_mul_f32 v23, v23, v17
v_accvgpr_write_b32 a76, v20
v_accvgpr_write_b32 a77, v21
v_accvgpr_write_b32 a78, v22
v_accvgpr_write_b32 a79, v23
v_accvgpr_read_b32 v20, a80
v_accvgpr_read_b32 v21, a81
v_accvgpr_read_b32 v22, a82
v_accvgpr_read_b32 v23, a83
v_mul_f32 v20, v20, v16
v_mul_f32 v21, v21, v16
v_mul_f32 v22, v22, v16
v_mul_f32 v23, v23, v16
v_accvgpr_write_b32 a80, v20
v_accvgpr_write_b32 a81, v21
v_accvgpr_write_b32 a82, v22
v_accvgpr_write_b32 a83, v23
v_accvgpr_read_b32 v20, a84
v_accvgpr_read_b32 v21, a85
v_accvgpr_read_b32 v22, a86
v_accvgpr_read_b32 v23, a87
v_mul_f32 v20, v20, v17
v_mul_f32 v21, v21, v17
v_mul_f32 v22, v22, v17
v_mul_f32 v23, v23, v17
v_accvgpr_write_b32 a84, v20
v_accvgpr_write_b32 a85, v21
v_accvgpr_write_b32 a86, v22
v_accvgpr_write_b32 a87, v23
v_accvgpr_read_b32 v20, a88
v_accvgpr_read_b32 v21, a89
v_accvgpr_read_b32 v22, a90
v_accvgpr_read_b32 v23, a91
v_mul_f32 v20, v20, v16
v_mul_f32 v21, v21, v16
v_mul_f32 v22, v22, v16
v_mul_f32 v23, v23, v16
v_accvgpr_write_b32 a88, v20
v_accvgpr_write_b32 a89, v21
v_accvgpr_write_b32 a90, v22
v_accvgpr_write_b32 a91, v23
v_accvgpr_read_b32 v20, a92
v_accvgpr_read_b32 v21, a93
v_accvgpr_read_b32 v22, a94
v_accvgpr_read_b32 v23, a95
v_mul_f32 v20, v20, v17
v_mul_f32 v21, v21, v17
v_mul_f32 v22, v22, v17
v_mul_f32 v23, v23, v17
v_accvgpr_write_b32 a92, v20
v_accvgpr_write_b32 a93, v21
v_accvgpr_write_b32 a94, v22
v_accvgpr_write_b32 a95, v23
v_accvgpr_read_b32 v20, a96
v_accvgpr_read_b32 v21, a97
v_accvgpr_read_b32 v22, a98
v_accvgpr_read_b32 v23, a99
v_mul_f32 v20, v20, v16
v_mul_f32 v21, v21, v16
v_mul_f32 v22, v22, v16
v_mul_f32 v23, v23, v16
v_accvgpr_write_b32 a96, v20
v_accvgpr_write_b32 a97, v21
v_accvgpr_write_b32 a98, v22
v_accvgpr_write_b32 a99, v23
v_accvgpr_read_b32 v20, a100
v_accvgpr_read_b32 v21, a101
v_accvgpr_read_b32 v22, a102
v_accvgpr_read_b32 v23, a103
v_mul_f32 v20, v20, v17
v_mul_f32 v21, v21, v17
v_mul_f32 v22, v22, v17
v_mul_f32 v23, v23, v17
v_accvgpr_write_b32 a100, v20
v_accvgpr_write_b32 a101, v21
v_accvgpr_write_b32 a102, v22
v_accvgpr_write_b32 a103, v23
v_accvgpr_read_b32 v20, a104
v_accvgpr_read_b32 v21, a105
v_accvgpr_read_b32 v22, a106
v_accvgpr_read_b32 v23, a107
v_mul_f32 v20, v20, v16
v_mul_f32 v21, v21, v16
v_mul_f32 v22, v22, v16
v_mul_f32 v23, v23, v16
v_accvgpr_write_b32 a104, v20
v_accvgpr_write_b32 a105, v21
v_accvgpr_write_b32 a106, v22
v_accvgpr_write_b32 a107, v23
v_accvgpr_read_b32 v20, a108
v_accvgpr_read_b32 v21, a109
v_accvgpr_read_b32 v22, a110
v_accvgpr_read_b32 v23, a111
v_mul_f32 v20, v20, v17
v_mul_f32 v21, v21, v17
v_mul_f32 v22, v22, v17
v_mul_f32 v23, v23, v17
v_accvgpr_write_b32 a108, v20
v_accvgpr_write_b32 a109, v21
v_accvgpr_write_b32 a110, v22
v_accvgpr_write_b32 a111, v23
v_accvgpr_read_b32 v20, a112
v_accvgpr_read_b32 v21, a113
v_accvgpr_read_b32 v22, a114
v_accvgpr_read_b32 v23, a115
v_mul_f32 v20, v20, v16
v_mul_f32 v21, v21, v16
v_mul_f32 v22, v22, v16
v_mul_f32 v23, v23, v16
v_accvgpr_write_b32 a112, v20
v_accvgpr_write_b32 a113, v21
v_accvgpr_write_b32 a114, v22
v_accvgpr_write_b32 a115, v23
v_accvgpr_read_b32 v20, a116
v_accvgpr_read_b32 v21, a117
v_accvgpr_read_b32 v22, a118
v_accvgpr_read_b32 v23, a119
v_mul_f32 v20, v20, v17
v_mul_f32 v21, v21, v17
v_mul_f32 v22, v22, v17
v_mul_f32 v23, v23, v17
v_accvgpr_write_b32 a116, v20
v_accvgpr_write_b32 a117, v21
v_accvgpr_write_b32 a118, v22
v_accvgpr_write_b32 a119, v23
v_accvgpr_read_b32 v20, a120
v_accvgpr_read_b32 v21, a121
v_accvgpr_read_b32 v22, a122
v_accvgpr_read_b32 v23, a123
v_mul_f32 v20, v20, v16
v_mul_f32 v21, v21, v16
v_mul_f32 v22, v22, v16
v_mul_f32 v23, v23, v16
v_accvgpr_write_b32 a120, v20
v_accvgpr_write_b32 a121, v21
v_accvgpr_write_b32 a122, v22
v_accvgpr_write_b32 a123, v23
v_accvgpr_read_b32 v20, a124
v_accvgpr_read_b32 v21, a125
v_accvgpr_read_b32 v22, a126
v_accvgpr_read_b32 v23, a127
v_mul_f32 v20, v20, v17
v_mul_f32 v21, v21, v17
v_mul_f32 v22, v22, v17
v_mul_f32 v23, v23, v17
v_accvgpr_write_b32 a124, v20
v_accvgpr_write_b32 a125, v21
v_accvgpr_write_b32 a126, v22
v_accvgpr_write_b32 a127, v23
v_lshlrev_b32 v20, 16, v144
v_and_b32 v21, 0xffff0000, v144
v_mul_f32 v20, v20, v16
v_mul_f32 v21, v21, v16
v_cvt_pk_bf16_f32 v144, v20, v21
v_lshlrev_b32 v20, 16, v145
v_and_b32 v21, 0xffff0000, v145
v_mul_f32 v20, v20, v16
v_mul_f32 v21, v21, v16
v_cvt_pk_bf16_f32 v145, v20, v21
v_lshlrev_b32 v20, 16, v146
v_and_b32 v21, 0xffff0000, v146
v_mul_f32 v20, v20, v16
v_mul_f32 v21, v21, v16
v_cvt_pk_bf16_f32 v146, v20, v21
v_lshlrev_b32 v20, 16, v147
v_and_b32 v21, 0xffff0000, v147
v_mul_f32 v20, v20, v16
v_mul_f32 v21, v21, v16
v_cvt_pk_bf16_f32 v147, v20, v21
v_lshlrev_b32 v20, 16, v148
v_and_b32 v21, 0xffff0000, v148
v_mul_f32 v20, v20, v17
v_mul_f32 v21, v21, v17
v_cvt_pk_bf16_f32 v148, v20, v21
v_lshlrev_b32 v20, 16, v149
v_and_b32 v21, 0xffff0000, v149
v_mul_f32 v20, v20, v17
v_mul_f32 v21, v21, v17
v_cvt_pk_bf16_f32 v149, v20, v21
v_lshlrev_b32 v20, 16, v150
v_and_b32 v21, 0xffff0000, v150
v_mul_f32 v20, v20, v17
v_mul_f32 v21, v21, v17
v_cvt_pk_bf16_f32 v150, v20, v21
v_lshlrev_b32 v20, 16, v151
v_and_b32 v21, 0xffff0000, v151
v_mul_f32 v20, v20, v17
v_mul_f32 v21, v21, v17
v_cvt_pk_bf16_f32 v151, v20, v21
v_lshlrev_b32 v20, 16, v152
v_and_b32 v21, 0xffff0000, v152
v_mul_f32 v20, v20, v16
v_mul_f32 v21, v21, v16
v_cvt_pk_bf16_f32 v152, v20, v21
v_lshlrev_b32 v20, 16, v153
v_and_b32 v21, 0xffff0000, v153
v_mul_f32 v20, v20, v16
v_mul_f32 v21, v21, v16
v_cvt_pk_bf16_f32 v153, v20, v21
v_lshlrev_b32 v20, 16, v154
v_and_b32 v21, 0xffff0000, v154
v_mul_f32 v20, v20, v16
v_mul_f32 v21, v21, v16
v_cvt_pk_bf16_f32 v154, v20, v21
v_lshlrev_b32 v20, 16, v155
v_and_b32 v21, 0xffff0000, v155
v_mul_f32 v20, v20, v16
v_mul_f32 v21, v21, v16
v_cvt_pk_bf16_f32 v155, v20, v21
v_lshlrev_b32 v20, 16, v156
v_and_b32 v21, 0xffff0000, v156
v_mul_f32 v20, v20, v17
v_mul_f32 v21, v21, v17
v_cvt_pk_bf16_f32 v156, v20, v21
v_lshlrev_b32 v20, 16, v157
v_and_b32 v21, 0xffff0000, v157
v_mul_f32 v20, v20, v17
v_mul_f32 v21, v21, v17
v_cvt_pk_bf16_f32 v157, v20, v21
v_lshlrev_b32 v20, 16, v158
v_and_b32 v21, 0xffff0000, v158
v_mul_f32 v20, v20, v17
v_mul_f32 v21, v21, v17
v_cvt_pk_bf16_f32 v158, v20, v21
v_lshlrev_b32 v20, 16, v159
v_and_b32 v21, 0xffff0000, v159
v_mul_f32 v20, v20, v17
v_mul_f32 v21, v21, v17
v_cvt_pk_bf16_f32 v159, v20, v21
v_lshlrev_b32 v20, 16, v160
v_and_b32 v21, 0xffff0000, v160
v_mul_f32 v20, v20, v16
v_mul_f32 v21, v21, v16
v_cvt_pk_bf16_f32 v160, v20, v21
v_lshlrev_b32 v20, 16, v161
v_and_b32 v21, 0xffff0000, v161
v_mul_f32 v20, v20, v16
v_mul_f32 v21, v21, v16
v_cvt_pk_bf16_f32 v161, v20, v21
v_lshlrev_b32 v20, 16, v162
v_and_b32 v21, 0xffff0000, v162
v_mul_f32 v20, v20, v16
v_mul_f32 v21, v21, v16
v_cvt_pk_bf16_f32 v162, v20, v21
v_lshlrev_b32 v20, 16, v163
v_and_b32 v21, 0xffff0000, v163
v_mul_f32 v20, v20, v16
v_mul_f32 v21, v21, v16
v_cvt_pk_bf16_f32 v163, v20, v21
v_lshlrev_b32 v20, 16, v164
v_and_b32 v21, 0xffff0000, v164
v_mul_f32 v20, v20, v17
v_mul_f32 v21, v21, v17
v_cvt_pk_bf16_f32 v164, v20, v21
v_lshlrev_b32 v20, 16, v165
v_and_b32 v21, 0xffff0000, v165
v_mul_f32 v20, v20, v17
v_mul_f32 v21, v21, v17
v_cvt_pk_bf16_f32 v165, v20, v21
v_lshlrev_b32 v20, 16, v166
v_and_b32 v21, 0xffff0000, v166
v_mul_f32 v20, v20, v17
v_mul_f32 v21, v21, v17
v_cvt_pk_bf16_f32 v166, v20, v21
v_lshlrev_b32 v20, 16, v167
v_and_b32 v21, 0xffff0000, v167
v_mul_f32 v20, v20, v17
v_mul_f32 v21, v21, v17
v_cvt_pk_bf16_f32 v167, v20, v21
v_lshlrev_b32 v20, 16, v168
v_and_b32 v21, 0xffff0000, v168
v_mul_f32 v20, v20, v16
v_mul_f32 v21, v21, v16
v_cvt_pk_bf16_f32 v168, v20, v21
v_lshlrev_b32 v20, 16, v169
v_and_b32 v21, 0xffff0000, v169
v_mul_f32 v20, v20, v16
v_mul_f32 v21, v21, v16
v_cvt_pk_bf16_f32 v169, v20, v21
v_lshlrev_b32 v20, 16, v170
v_and_b32 v21, 0xffff0000, v170
v_mul_f32 v20, v20, v16
v_mul_f32 v21, v21, v16
v_cvt_pk_bf16_f32 v170, v20, v21
v_lshlrev_b32 v20, 16, v171
v_and_b32 v21, 0xffff0000, v171
v_mul_f32 v20, v20, v16
v_mul_f32 v21, v21, v16
v_cvt_pk_bf16_f32 v171, v20, v21
v_lshlrev_b32 v20, 16, v172
v_and_b32 v21, 0xffff0000, v172
v_mul_f32 v20, v20, v17
v_mul_f32 v21, v21, v17
v_cvt_pk_bf16_f32 v172, v20, v21
v_lshlrev_b32 v20, 16, v173
v_and_b32 v21, 0xffff0000, v173
v_mul_f32 v20, v20, v17
v_mul_f32 v21, v21, v17
v_cvt_pk_bf16_f32 v173, v20, v21
v_lshlrev_b32 v20, 16, v174
v_and_b32 v21, 0xffff0000, v174
v_mul_f32 v20, v20, v17
v_mul_f32 v21, v21, v17
v_cvt_pk_bf16_f32 v174, v20, v21
v_lshlrev_b32 v20, 16, v175
v_and_b32 v21, 0xffff0000, v175
v_mul_f32 v20, v20, v17
v_mul_f32 v21, v21, v17
v_cvt_pk_bf16_f32 v175, v20, v21
v_lshlrev_b32 v20, 16, v176
v_and_b32 v21, 0xffff0000, v176
v_mul_f32 v20, v20, v16
v_mul_f32 v21, v21, v16
v_cvt_pk_bf16_f32 v176, v20, v21
v_lshlrev_b32 v20, 16, v177
v_and_b32 v21, 0xffff0000, v177
v_mul_f32 v20, v20, v16
v_mul_f32 v21, v21, v16
v_cvt_pk_bf16_f32 v177, v20, v21
v_lshlrev_b32 v20, 16, v178
v_and_b32 v21, 0xffff0000, v178
v_mul_f32 v20, v20, v16
v_mul_f32 v21, v21, v16
v_cvt_pk_bf16_f32 v178, v20, v21
v_lshlrev_b32 v20, 16, v179
v_and_b32 v21, 0xffff0000, v179
v_mul_f32 v20, v20, v16
v_mul_f32 v21, v21, v16
v_cvt_pk_bf16_f32 v179, v20, v21
v_lshlrev_b32 v20, 16, v180
v_and_b32 v21, 0xffff0000, v180
v_mul_f32 v20, v20, v17
v_mul_f32 v21, v21, v17
v_cvt_pk_bf16_f32 v180, v20, v21
v_lshlrev_b32 v20, 16, v181
v_and_b32 v21, 0xffff0000, v181
v_mul_f32 v20, v20, v17
v_mul_f32 v21, v21, v17
v_cvt_pk_bf16_f32 v181, v20, v21
v_lshlrev_b32 v20, 16, v182
v_and_b32 v21, 0xffff0000, v182
v_mul_f32 v20, v20, v17
v_mul_f32 v21, v21, v17
v_cvt_pk_bf16_f32 v182, v20, v21
v_lshlrev_b32 v20, 16, v183
v_and_b32 v21, 0xffff0000, v183
v_mul_f32 v20, v20, v17
v_mul_f32 v21, v21, v17
v_cvt_pk_bf16_f32 v183, v20, v21
v_lshlrev_b32 v20, 16, v184
v_and_b32 v21, 0xffff0000, v184
v_mul_f32 v20, v20, v16
v_mul_f32 v21, v21, v16
v_cvt_pk_bf16_f32 v184, v20, v21
v_lshlrev_b32 v20, 16, v185
v_and_b32 v21, 0xffff0000, v185
v_mul_f32 v20, v20, v16
v_mul_f32 v21, v21, v16
v_cvt_pk_bf16_f32 v185, v20, v21
v_lshlrev_b32 v20, 16, v186
v_and_b32 v21, 0xffff0000, v186
v_mul_f32 v20, v20, v16
v_mul_f32 v21, v21, v16
v_cvt_pk_bf16_f32 v186, v20, v21
v_lshlrev_b32 v20, 16, v187
v_and_b32 v21, 0xffff0000, v187
v_mul_f32 v20, v20, v16
v_mul_f32 v21, v21, v16
v_cvt_pk_bf16_f32 v187, v20, v21
v_lshlrev_b32 v20, 16, v188
v_and_b32 v21, 0xffff0000, v188
v_mul_f32 v20, v20, v17
v_mul_f32 v21, v21, v17
v_cvt_pk_bf16_f32 v188, v20, v21
v_lshlrev_b32 v20, 16, v189
v_and_b32 v21, 0xffff0000, v189
v_mul_f32 v20, v20, v17
v_mul_f32 v21, v21, v17
v_cvt_pk_bf16_f32 v189, v20, v21
v_lshlrev_b32 v20, 16, v190
v_and_b32 v21, 0xffff0000, v190
v_mul_f32 v20, v20, v17
v_mul_f32 v21, v21, v17
v_cvt_pk_bf16_f32 v190, v20, v21
v_lshlrev_b32 v20, 16, v191
v_and_b32 v21, 0xffff0000, v191
v_mul_f32 v20, v20, v17
v_mul_f32 v21, v21, v17
v_cvt_pk_bf16_f32 v191, v20, v21
v_lshlrev_b32 v20, 16, v192
v_and_b32 v21, 0xffff0000, v192
v_mul_f32 v20, v20, v16
v_mul_f32 v21, v21, v16
v_cvt_pk_bf16_f32 v192, v20, v21
v_lshlrev_b32 v20, 16, v193
v_and_b32 v21, 0xffff0000, v193
v_mul_f32 v20, v20, v16
v_mul_f32 v21, v21, v16
v_cvt_pk_bf16_f32 v193, v20, v21
v_lshlrev_b32 v20, 16, v194
v_and_b32 v21, 0xffff0000, v194
v_mul_f32 v20, v20, v16
v_mul_f32 v21, v21, v16
v_cvt_pk_bf16_f32 v194, v20, v21
v_lshlrev_b32 v20, 16, v195
v_and_b32 v21, 0xffff0000, v195
v_mul_f32 v20, v20, v16
v_mul_f32 v21, v21, v16
v_cvt_pk_bf16_f32 v195, v20, v21
v_lshlrev_b32 v20, 16, v196
v_and_b32 v21, 0xffff0000, v196
v_mul_f32 v20, v20, v17
v_mul_f32 v21, v21, v17
v_cvt_pk_bf16_f32 v196, v20, v21
v_lshlrev_b32 v20, 16, v197
v_and_b32 v21, 0xffff0000, v197
v_mul_f32 v20, v20, v17
v_mul_f32 v21, v21, v17
v_cvt_pk_bf16_f32 v197, v20, v21
v_lshlrev_b32 v20, 16, v198
v_and_b32 v21, 0xffff0000, v198
v_mul_f32 v20, v20, v17
v_mul_f32 v21, v21, v17
v_cvt_pk_bf16_f32 v198, v20, v21
v_lshlrev_b32 v20, 16, v199
v_and_b32 v21, 0xffff0000, v199
v_mul_f32 v20, v20, v17
v_mul_f32 v21, v21, v17
v_cvt_pk_bf16_f32 v199, v20, v21
v_lshlrev_b32 v20, 16, v200
v_and_b32 v21, 0xffff0000, v200
v_mul_f32 v20, v20, v16
v_mul_f32 v21, v21, v16
v_cvt_pk_bf16_f32 v200, v20, v21
v_lshlrev_b32 v20, 16, v201
v_and_b32 v21, 0xffff0000, v201
v_mul_f32 v20, v20, v16
v_mul_f32 v21, v21, v16
v_cvt_pk_bf16_f32 v201, v20, v21
v_lshlrev_b32 v20, 16, v202
v_and_b32 v21, 0xffff0000, v202
v_mul_f32 v20, v20, v16
v_mul_f32 v21, v21, v16
v_cvt_pk_bf16_f32 v202, v20, v21
v_lshlrev_b32 v20, 16, v203
v_and_b32 v21, 0xffff0000, v203
v_mul_f32 v20, v20, v16
v_mul_f32 v21, v21, v16
v_cvt_pk_bf16_f32 v203, v20, v21
v_lshlrev_b32 v20, 16, v204
v_and_b32 v21, 0xffff0000, v204
v_mul_f32 v20, v20, v17
v_mul_f32 v21, v21, v17
v_cvt_pk_bf16_f32 v204, v20, v21
v_lshlrev_b32 v20, 16, v205
v_and_b32 v21, 0xffff0000, v205
v_mul_f32 v20, v20, v17
v_mul_f32 v21, v21, v17
v_cvt_pk_bf16_f32 v205, v20, v21
v_lshlrev_b32 v20, 16, v206
v_and_b32 v21, 0xffff0000, v206
v_mul_f32 v20, v20, v17
v_mul_f32 v21, v21, v17
v_cvt_pk_bf16_f32 v206, v20, v21
v_lshlrev_b32 v20, 16, v207
v_and_b32 v21, 0xffff0000, v207
v_mul_f32 v20, v20, v17
v_mul_f32 v21, v21, v17
v_cvt_pk_bf16_f32 v207, v20, v21
v_exp_f32 v16, v64
v_exp_f32 v17, v65
v_exp_f32 v18, v66
v_exp_f32 v19, v67
v_exp_f32 v20, v68
v_exp_f32 v21, v69
v_exp_f32 v22, v70
v_exp_f32 v23, v71
v_exp_f32 v24, v72
v_exp_f32 v25, v73
v_exp_f32 v26, v74
v_exp_f32 v27, v75
v_exp_f32 v28, v76
v_exp_f32 v29, v77
v_exp_f32 v30, v78
v_exp_f32 v31, v79
s_nop 0
v_add_f32 v14, v12, v16
v_add_f32 v14, v14, v17
v_add_f32 v14, v14, v18
v_add_f32 v14, v14, v19
v_add_f32 v14, v14, v20
v_add_f32 v14, v14, v21
v_add_f32 v14, v14, v22
v_add_f32 v14, v14, v23
v_add_f32 v15, v13, v24
v_add_f32 v15, v15, v25
v_add_f32 v15, v15, v26
v_add_f32 v15, v15, v27
v_add_f32 v15, v15, v28
v_add_f32 v15, v15, v29
v_add_f32 v15, v15, v30
v_add_f32 v15, v15, v31
v_cvt_pk_bf16_f32 v40, v16, v17
v_cvt_pk_bf16_f32 v41, v18, v19
v_cvt_pk_bf16_f32 v42, v20, v21
v_cvt_pk_bf16_f32 v43, v22, v23
v_cvt_pk_bf16_f32 v44, v24, v25
v_cvt_pk_bf16_f32 v45, v26, v27
v_cvt_pk_bf16_f32 v46, v28, v29
v_cvt_pk_bf16_f32 v47, v30, v31
s_nop 1
s_branch L_back_f
L_rare_e:
v_max3_f32 v18, v48, v49, v50
v_max3_f32 v18, v18, v51, v52
v_max3_f32 v18, v18, v53, v54
v_max_f32 v18, v18, v55
v_mov_b32 v19, v18
s_nop 1
v_permlane32_swap_b32 v19, v18
v_max_f32 v18, v18, v19
v_mov_b32 v19, v18
s_nop 1
v_permlane16_swap_b32 v19, v18
v_max_f32 v18, v18, v19
v_ceil_f32 v18, v18
v_max_f32 v18, 0, v18
v_exp_f32 v16, -v18
v_add_f32 v10, v10, v18
v_sub_f32 v248, v248, v18
v_sub_f32 v249, v249, v18
v_sub_f32 v250, v250, v18
v_sub_f32 v251, v251, v18
v_sub_f32 v48, v48, v18
v_sub_f32 v49, v49, v18
v_sub_f32 v50, v50, v18
v_sub_f32 v51, v51, v18
v_sub_f32 v52, v52, v18
v_sub_f32 v53, v53, v18
v_sub_f32 v54, v54, v18
v_sub_f32 v55, v55, v18
v_sub_f32 v64, v64, v18
v_sub_f32 v65, v65, v18
v_sub_f32 v66, v66, v18
v_sub_f32 v67, v67, v18
v_sub_f32 v68, v68, v18
v_sub_f32 v69, v69, v18
v_sub_f32 v70, v70, v18
v_sub_f32 v71, v71, v18
v_mul_f32 v14, v14, v16
v_max3_f32 v18, v56, v57, v58
v_max3_f32 v18, v18, v59, v60
v_max3_f32 v18, v18, v61, v62
v_max_f32 v18, v18, v63
v_mov_b32 v19, v18
s_nop 1
v_permlane32_swap_b32 v19, v18
v_max_f32 v18, v18, v19
v_mov_b32 v19, v18
s_nop 1
v_permlane16_swap_b32 v19, v18
v_max_f32 v18, v18, v19
v_ceil_f32 v18, v18
v_max_f32 v18, 0, v18
v_exp_f32 v17, -v18
v_add_f32 v11, v11, v18
v_sub_f32 v252, v252, v18
v_sub_f32 v253, v253, v18
v_sub_f32 v254, v254, v18
v_sub_f32 v255, v255, v18
v_sub_f32 v56, v56, v18
v_sub_f32 v57, v57, v18
v_sub_f32 v58, v58, v18
v_sub_f32 v59, v59, v18
v_sub_f32 v60, v60, v18
v_sub_f32 v61, v61, v18
v_sub_f32 v62, v62, v18
v_sub_f32 v63, v63, v18
v_sub_f32 v72, v72, v18
v_sub_f32 v73, v73, v18
v_sub_f32 v74, v74, v18
v_sub_f32 v75, v75, v18
v_sub_f32 v76, v76, v18
v_sub_f32 v77, v77, v18
v_sub_f32 v78, v78, v18
v_sub_f32 v79, v79, v18
v_mul_f32 v15, v15, v17
s_nop 7
s_nop 7
v_accvgpr_read_b32 v20, a0
v_accvgpr_read_b32 v21, a1
v_accvgpr_read_b32 v22, a2
v_accvgpr_read_b32 v23, a3
v_mul_f32 v20, v20, v16
v_mul_f32 v21, v21, v16
v_mul_f32 v22, v22, v16
v_mul_f32 v23, v23, v16
v_accvgpr_write_b32 a0, v20
v_accvgpr_write_b32 a1, v21
v_accvgpr_write_b32 a2, v22
v_accvgpr_write_b32 a3, v23
v_accvgpr_read_b32 v20, a4
v_accvgpr_read_b32 v21, a5
v_accvgpr_read_b32 v22, a6
v_accvgpr_read_b32 v23, a7
v_mul_f32 v20, v20, v17
v_mul_f32 v21, v21, v17
v_mul_f32 v22, v22, v17
v_mul_f32 v23, v23, v17
v_accvgpr_write_b32 a4, v20
v_accvgpr_write_b32 a5, v21
v_accvgpr_write_b32 a6, v22
v_accvgpr_write_b32 a7, v23
v_accvgpr_read_b32 v20, a8
v_accvgpr_read_b32 v21, a9
v_accvgpr_read_b32 v22, a10
v_accvgpr_read_b32 v23, a11
v_mul_f32 v20, v20, v16
v_mul_f32 v21, v21, v16
v_mul_f32 v22, v22, v16
v_mul_f32 v23, v23, v16
v_accvgpr_write_b32 a8, v20
v_accvgpr_write_b32 a9, v21
v_accvgpr_write_b32 a10, v22
v_accvgpr_write_b32 a11, v23
v_accvgpr_read_b32 v20, a12
v_accvgpr_read_b32 v21, a13
v_accvgpr_read_b32 v22, a14
v_accvgpr_read_b32 v23, a15
v_mul_f32 v20, v20, v17
v_mul_f32 v21, v21, v17
v_mul_f32 v22, v22, v17
v_mul_f32 v23, v23, v17
v_accvgpr_write_b32 a12, v20
v_accvgpr_write_b32 a13, v21
v_accvgpr_write_b32 a14, v22
v_accvgpr_write_b32 a15, v23
v_accvgpr_read_b32 v20, a16
v_accvgpr_read_b32 v21, a17
v_accvgpr_read_b32 v22, a18
v_accvgpr_read_b32 v23, a19
v_mul_f32 v20, v20, v16
v_mul_f32 v21, v21, v16
v_mul_f32 v22, v22, v16
v_mul_f32 v23, v23, v16
v_accvgpr_write_b32 a16, v20
v_accvgpr_write_b32 a17, v21
v_accvgpr_write_b32 a18, v22
v_accvgpr_write_b32 a19, v23
v_accvgpr_read_b32 v20, a20
v_accvgpr_read_b32 v21, a21
v_accvgpr_read_b32 v22, a22
v_accvgpr_read_b32 v23, a23
v_mul_f32 v20, v20, v17
v_mul_f32 v21, v21, v17
v_mul_f32 v22, v22, v17
v_mul_f32 v23, v23, v17
v_accvgpr_write_b32 a20, v20
v_accvgpr_write_b32 a21, v21
v_accvgpr_write_b32 a22, v22
v_accvgpr_write_b32 a23, v23
v_accvgpr_read_b32 v20, a24
v_accvgpr_read_b32 v21, a25
v_accvgpr_read_b32 v22, a26
v_accvgpr_read_b32 v23, a27
v_mul_f32 v20, v20, v16
v_mul_f32 v21, v21, v16
v_mul_f32 v22, v22, v16
v_mul_f32 v23, v23, v16
v_accvgpr_write_b32 a24, v20
v_accvgpr_write_b32 a25, v21
v_accvgpr_write_b32 a26, v22
v_accvgpr_write_b32 a27, v23
v_accvgpr_read_b32 v20, a28
v_accvgpr_read_b32 v21, a29
v_accvgpr_read_b32 v22, a30
v_accvgpr_read_b32 v23, a31
v_mul_f32 v20, v20, v17
v_mul_f32 v21, v21, v17
v_mul_f32 v22, v22, v17
v_mul_f32 v23, v23, v17
v_accvgpr_write_b32 a28, v20
v_accvgpr_write_b32 a29, v21
v_accvgpr_write_b32 a30, v22
v_accvgpr_write_b32 a31, v23
v_accvgpr_read_b32 v20, a32
v_accvgpr_read_b32 v21, a33
v_accvgpr_read_b32 v22, a34
v_accvgpr_read_b32 v23, a35
v_mul_f32 v20, v20, v16
v_mul_f32 v21, v21, v16
v_mul_f32 v22, v22, v16
v_mul_f32 v23, v23, v16
v_accvgpr_write_b32 a32, v20
v_accvgpr_write_b32 a33, v21
v_accvgpr_write_b32 a34, v22
v_accvgpr_write_b32 a35, v23
v_accvgpr_read_b32 v20, a36
v_accvgpr_read_b32 v21, a37
v_accvgpr_read_b32 v22, a38
v_accvgpr_read_b32 v23, a39
v_mul_f32 v20, v20, v17
v_mul_f32 v21, v21, v17
v_mul_f32 v22, v22, v17
v_mul_f32 v23, v23, v17
v_accvgpr_write_b32 a36, v20
v_accvgpr_write_b32 a37, v21
v_accvgpr_write_b32 a38, v22
v_accvgpr_write_b32 a39, v23
v_accvgpr_read_b32 v20, a40
v_accvgpr_read_b32 v21, a41
v_accvgpr_read_b32 v22, a42
v_accvgpr_read_b32 v23, a43
v_mul_f32 v20, v20, v16
v_mul_f32 v21, v21, v16
v_mul_f32 v22, v22, v16
v_mul_f32 v23, v23, v16
v_accvgpr_write_b32 a40, v20
v_accvgpr_write_b32 a41, v21
v_accvgpr_write_b32 a42, v22
v_accvgpr_write_b32 a43, v23
v_accvgpr_read_b32 v20, a44
v_accvgpr_read_b32 v21, a45
v_accvgpr_read_b32 v22, a46
v_accvgpr_read_b32 v23, a47
v_mul_f32 v20, v20, v17
v_mul_f32 v21, v21, v17
v_mul_f32 v22, v22, v17
v_mul_f32 v23, v23, v17
v_accvgpr_write_b32 a44, v20
v_accvgpr_write_b32 a45, v21
v_accvgpr_write_b32 a46, v22
v_accvgpr_write_b32 a47, v23
v_accvgpr_read_b32 v20, a48
v_accvgpr_read_b32 v21, a49
v_accvgpr_read_b32 v22, a50
v_accvgpr_read_b32 v23, a51
v_mul_f32 v20, v20, v16
v_mul_f32 v21, v21, v16
v_mul_f32 v22, v22, v16
v_mul_f32 v23, v23, v16
v_accvgpr_write_b32 a48, v20
v_accvgpr_write_b32 a49, v21
v_accvgpr_write_b32 a50, v22
v_accvgpr_write_b32 a51, v23
v_accvgpr_read_b32 v20, a52
v_accvgpr_read_b32 v21, a53
v_accvgpr_read_b32 v22, a54
v_accvgpr_read_b32 v23, a55
v_mul_f32 v20, v20, v17
v_mul_f32 v21, v21, v17
v_mul_f32 v22, v22, v17
v_mul_f32 v23, v23, v17
v_accvgpr_write_b32 a52, v20
v_accvgpr_write_b32 a53, v21
v_accvgpr_write_b32 a54, v22
v_accvgpr_write_b32 a55, v23
v_accvgpr_read_b32 v20, a56
v_accvgpr_read_b32 v21, a57
v_accvgpr_read_b32 v22, a58
v_accvgpr_read_b32 v23, a59
v_mul_f32 v20, v20, v16
v_mul_f32 v21, v21, v16
v_mul_f32 v22, v22, v16
v_mul_f32 v23, v23, v16
v_accvgpr_write_b32 a56, v20
v_accvgpr_write_b32 a57, v21
v_accvgpr_write_b32 a58, v22
v_accvgpr_write_b32 a59, v23
v_accvgpr_read_b32 v20, a60
v_accvgpr_read_b32 v21, a61
v_accvgpr_read_b32 v22, a62
v_accvgpr_read_b32 v23, a63
v_mul_f32 v20, v20, v17
v_mul_f32 v21, v21, v17
v_mul_f32 v22, v22, v17
v_mul_f32 v23, v23, v17
v_accvgpr_write_b32 a60, v20
v_accvgpr_write_b32 a61, v21
v_accvgpr_write_b32 a62, v22
v_accvgpr_write_b32 a63, v23
v_accvgpr_read_b32 v20, a64
v_accvgpr_read_b32 v21, a65
v_accvgpr_read_b32 v22, a66
v_accvgpr_read_b32 v23, a67
v_mul_f32 v20, v20, v16
v_mul_f32 v21, v21, v16
v_mul_f32 v22, v22, v16
v_mul_f32 v23, v23, v16
v_accvgpr_write_b32 a64, v20
v_accvgpr_write_b32 a65, v21
v_accvgpr_write_b32 a66, v22
v_accvgpr_write_b32 a67, v23
v_accvgpr_read_b32 v20, a68
v_accvgpr_read_b32 v21, a69
v_accvgpr_read_b32 v22, a70
v_accvgpr_read_b32 v23, a71
v_mul_f32 v20, v20, v17
v_mul_f32 v21, v21, v17
v_mul_f32 v22, v22, v17
v_mul_f32 v23, v23, v17
v_accvgpr_write_b32 a68, v20
v_accvgpr_write_b32 a69, v21
v_accvgpr_write_b32 a70, v22
v_accvgpr_write_b32 a71, v23
v_accvgpr_read_b32 v20, a72
v_accvgpr_read_b32 v21, a73
v_accvgpr_read_b32 v22, a74
v_accvgpr_read_b32 v23, a75
v_mul_f32 v20, v20, v16
v_mul_f32 v21, v21, v16
v_mul_f32 v22, v22, v16
v_mul_f32 v23, v23, v16
v_accvgpr_write_b32 a72, v20
v_accvgpr_write_b32 a73, v21
v_accvgpr_write_b32 a74, v22
v_accvgpr_write_b32 a75, v23
v_accvgpr_read_b32 v20, a76
v_accvgpr_read_b32 v21, a77
v_accvgpr_read_b32 v22, a78
v_accvgpr_read_b32 v23, a79
v_mul_f32 v20, v20, v17
v_mul_f32 v21, v21, v17
v_mul_f32 v22, v22, v17
v_mul_f32 v23, v23, v17
v_accvgpr_write_b32 a76, v20
v_accvgpr_write_b32 a77, v21
v_accvgpr_write_b32 a78, v22
v_accvgpr_write_b32 a79, v23
v_accvgpr_read_b32 v20, a80
v_accvgpr_read_b32 v21, a81
v_accvgpr_read_b32 v22, a82
v_accvgpr_read_b32 v23, a83
v_mul_f32 v20, v20, v16
v_mul_f32 v21, v21, v16
v_mul_f32 v22, v22, v16
v_mul_f32 v23, v23, v16
v_accvgpr_write_b32 a80, v20
v_accvgpr_write_b32 a81, v21
v_accvgpr_write_b32 a82, v22
v_accvgpr_write_b32 a83, v23
v_accvgpr_read_b32 v20, a84
v_accvgpr_read_b32 v21, a85
v_accvgpr_read_b32 v22, a86
v_accvgpr_read_b32 v23, a87
v_mul_f32 v20, v20, v17
v_mul_f32 v21, v21, v17
v_mul_f32 v22, v22, v17
v_mul_f32 v23, v23, v17
v_accvgpr_write_b32 a84, v20
v_accvgpr_write_b32 a85, v21
v_accvgpr_write_b32 a86, v22
v_accvgpr_write_b32 a87, v23
v_accvgpr_read_b32 v20, a88
v_accvgpr_read_b32 v21, a89
v_accvgpr_read_b32 v22, a90
v_accvgpr_read_b32 v23, a91
v_mul_f32 v20, v20, v16
v_mul_f32 v21, v21, v16
v_mul_f32 v22, v22, v16
v_mul_f32 v23, v23, v16
v_accvgpr_write_b32 a88, v20
v_accvgpr_write_b32 a89, v21
v_accvgpr_write_b32 a90, v22
v_accvgpr_write_b32 a91, v23
v_accvgpr_read_b32 v20, a92
v_accvgpr_read_b32 v21, a93
v_accvgpr_read_b32 v22, a94
v_accvgpr_read_b32 v23, a95
v_mul_f32 v20, v20, v17
v_mul_f32 v21, v21, v17
v_mul_f32 v22, v22, v17
v_mul_f32 v23, v23, v17
v_accvgpr_write_b32 a92, v20
v_accvgpr_write_b32 a93, v21
v_accvgpr_write_b32 a94, v22
v_accvgpr_write_b32 a95, v23
v_accvgpr_read_b32 v20, a96
v_accvgpr_read_b32 v21, a97
v_accvgpr_read_b32 v22, a98
v_accvgpr_read_b32 v23, a99
v_mul_f32 v20, v20, v16
v_mul_f32 v21, v21, v16
v_mul_f32 v22, v22, v16
v_mul_f32 v23, v23, v16
v_accvgpr_write_b32 a96, v20
v_accvgpr_write_b32 a97, v21
v_accvgpr_write_b32 a98, v22
v_accvgpr_write_b32 a99, v23
v_accvgpr_read_b32 v20, a100
v_accvgpr_read_b32 v21, a101
v_accvgpr_read_b32 v22, a102
v_accvgpr_read_b32 v23, a103
v_mul_f32 v20, v20, v17
v_mul_f32 v21, v21, v17
v_mul_f32 v22, v22, v17
v_mul_f32 v23, v23, v17
v_accvgpr_write_b32 a100, v20
v_accvgpr_write_b32 a101, v21
v_accvgpr_write_b32 a102, v22
v_accvgpr_write_b32 a103, v23
v_accvgpr_read_b32 v20, a104
v_accvgpr_read_b32 v21, a105
v_accvgpr_read_b32 v22, a106
v_accvgpr_read_b32 v23, a107
v_mul_f32 v20, v20, v16
v_mul_f32 v21, v21, v16
v_mul_f32 v22, v22, v16
v_mul_f32 v23, v23, v16
v_accvgpr_write_b32 a104, v20
v_accvgpr_write_b32 a105, v21
v_accvgpr_write_b32 a106, v22
v_accvgpr_write_b32 a107, v23
v_accvgpr_read_b32 v20, a108
v_accvgpr_read_b32 v21, a109
v_accvgpr_read_b32 v22, a110
v_accvgpr_read_b32 v23, a111
v_mul_f32 v20, v20, v17
v_mul_f32 v21, v21, v17
v_mul_f32 v22, v22, v17
v_mul_f32 v23, v23, v17
v_accvgpr_write_b32 a108, v20
v_accvgpr_write_b32 a109, v21
v_accvgpr_write_b32 a110, v22
v_accvgpr_write_b32 a111, v23
v_accvgpr_read_b32 v20, a112
v_accvgpr_read_b32 v21, a113
v_accvgpr_read_b32 v22, a114
v_accvgpr_read_b32 v23, a115
v_mul_f32 v20, v20, v16
v_mul_f32 v21, v21, v16
v_mul_f32 v22, v22, v16
v_mul_f32 v23, v23, v16
v_accvgpr_write_b32 a112, v20
v_accvgpr_write_b32 a113, v21
v_accvgpr_write_b32 a114, v22
v_accvgpr_write_b32 a115, v23
v_accvgpr_read_b32 v20, a116
v_accvgpr_read_b32 v21, a117
v_accvgpr_read_b32 v22, a118
v_accvgpr_read_b32 v23, a119
v_mul_f32 v20, v20, v17
v_mul_f32 v21, v21, v17
v_mul_f32 v22, v22, v17
v_mul_f32 v23, v23, v17
v_accvgpr_write_b32 a116, v20
v_accvgpr_write_b32 a117, v21
v_accvgpr_write_b32 a118, v22
v_accvgpr_write_b32 a119, v23
v_accvgpr_read_b32 v20, a120
v_accvgpr_read_b32 v21, a121
v_accvgpr_read_b32 v22, a122
v_accvgpr_read_b32 v23, a123
v_mul_f32 v20, v20, v16
v_mul_f32 v21, v21, v16
v_mul_f32 v22, v22, v16
v_mul_f32 v23, v23, v16
v_accvgpr_write_b32 a120, v20
v_accvgpr_write_b32 a121, v21
v_accvgpr_write_b32 a122, v22
v_accvgpr_write_b32 a123, v23
v_accvgpr_read_b32 v20, a124
v_accvgpr_read_b32 v21, a125
v_accvgpr_read_b32 v22, a126
v_accvgpr_read_b32 v23, a127
v_mul_f32 v20, v20, v17
v_mul_f32 v21, v21, v17
v_mul_f32 v22, v22, v17
v_mul_f32 v23, v23, v17
v_accvgpr_write_b32 a124, v20
v_accvgpr_write_b32 a125, v21
v_accvgpr_write_b32 a126, v22
v_accvgpr_write_b32 a127, v23
v_exp_f32 v16, v48
v_exp_f32 v17, v49
v_exp_f32 v18, v50
v_exp_f32 v19, v51
v_exp_f32 v20, v52
v_exp_f32 v21, v53
v_exp_f32 v22, v54
v_exp_f32 v23, v55
v_exp_f32 v24, v56
v_exp_f32 v25, v57
v_exp_f32 v26, v58
v_exp_f32 v27, v59
v_exp_f32 v28, v60
v_exp_f32 v29, v61
v_exp_f32 v30, v62
v_exp_f32 v31, v63
s_nop 0
v_add_f32 v12, v14, v16
v_add_f32 v12, v12, v17
v_add_f32 v12, v12, v18
v_add_f32 v12, v12, v19
v_add_f32 v12, v12, v20
v_add_f32 v12, v12, v21
v_add_f32 v12, v12, v22
v_add_f32 v12, v12, v23
v_add_f32 v13, v15, v24
v_add_f32 v13, v13, v25
v_add_f32 v13, v13, v26
v_add_f32 v13, v13, v27
v_add_f32 v13, v13, v28
v_add_f32 v13, v13, v29
v_add_f32 v13, v13, v30
v_add_f32 v13, v13, v31
v_cvt_pk_bf16_f32 v32, v16, v17
v_cvt_pk_bf16_f32 v33, v18, v19
v_cvt_pk_bf16_f32 v34, v20, v21
v_cvt_pk_bf16_f32 v35, v22, v23
v_cvt_pk_bf16_f32 v36, v24, v25
v_cvt_pk_bf16_f32 v37, v26, v27
v_cvt_pk_bf16_f32 v38, v28, v29
v_cvt_pk_bf16_f32 v39, v30, v31
s_nop 1
s_branch L_back_e
L_rare_o:
v_max3_f32 v18, v64, v65, v66
v_max3_f32 v18, v18, v67, v68
v_max3_f32 v18, v18, v69, v70
v_max_f32 v18, v18, v71
v_mov_b32 v19, v18
s_nop 1
v_permlane32_swap_b32 v19, v18
v_max_f32 v18, v18, v19
v_mov_b32 v19, v18
s_nop 1
v_permlane16_swap_b32 v19, v18
v_max_f32 v18, v18, v19
v_ceil_f32 v18, v18
v_max_f32 v18, 0, v18
v_exp_f32 v16, -v18
v_add_f32 v10, v10, v18
v_sub_f32 v248, v248, v18
v_sub_f32 v249, v249, v18
v_sub_f32 v250, v250, v18
v_sub_f32 v251, v251, v18
v_sub_f32 v64, v64, v18
v_sub_f32 v65, v65, v18
v_sub_f32 v66, v66, v18
v_sub_f32 v67, v67, v18
v_sub_f32 v68, v68, v18
v_sub_f32 v69, v69, v18
v_sub_f32 v70, v70, v18
v_sub_f32 v71, v71, v18
v_sub_f32 v48, v48, v18
v_sub_f32 v49, v49, v18
v_sub_f32 v50, v50, v18
v_sub_f32 v51, v51, v18
v_sub_f32 v52, v52, v18
v_sub_f32 v53, v53, v18
v_sub_f32 v54, v54, v18
v_sub_f32 v55, v55, v18
v_mul_f32 v12, v12, v16
v_max3_f32 v18, v72, v73, v74
v_max3_f32 v18, v18, v75, v76
v_max3_f32 v18, v18, v77, v78
v_max_f32 v18, v18, v79
v_mov_b32 v19, v18
s_nop 1
v_permlane32_swap_b32 v19, v18
v_max_f32 v18, v18, v19
v_mov_b32 v19, v18
s_nop 1
v_permlane16_swap_b32 v19, v18
v_max_f32 v18, v18, v19
v_ceil_f32 v18, v18
v_max_f32 v18, 0, v18
v_exp_f32 v17, -v18
v_add_f32 v11, v11, v18
v_sub_f32 v252, v252, v18
v_sub_f32 v253, v253, v18
v_sub_f32 v254, v254, v18
v_sub_f32 v255, v255, v18
v_sub_f32 v72, v72, v18
v_sub_f32 v73, v73, v18
v_sub_f32 v74, v74, v18
v_sub_f32 v75, v75, v18
v_sub_f32 v76, v76, v18
v_sub_f32 v77, v77, v18
v_sub_f32 v78, v78, v18
v_sub_f32 v79, v79, v18
v_sub_f32 v56, v56, v18
v_sub_f32 v57, v57, v18
v_sub_f32 v58, v58, v18
v_sub_f32 v59, v59, v18
v_sub_f32 v60, v60, v18
v_sub_f32 v61, v61, v18
v_sub_f32 v62, v62, v18
v_sub_f32 v63, v63, v18
v_mul_f32 v13, v13, v17
s_nop 7
s_nop 7
v_accvgpr_read_b32 v20, a0
v_accvgpr_read_b32 v21, a1
v_accvgpr_read_b32 v22, a2
v_accvgpr_read_b32 v23, a3
v_mul_f32 v20, v20, v16
v_mul_f32 v21, v21, v16
v_mul_f32 v22, v22, v16
v_mul_f32 v23, v23, v16
v_accvgpr_write_b32 a0, v20
v_accvgpr_write_b32 a1, v21
v_accvgpr_write_b32 a2, v22
v_accvgpr_write_b32 a3, v23
v_accvgpr_read_b32 v20, a4
v_accvgpr_read_b32 v21, a5
v_accvgpr_read_b32 v22, a6
v_accvgpr_read_b32 v23, a7
v_mul_f32 v20, v20, v17
v_mul_f32 v21, v21, v17
v_mul_f32 v22, v22, v17
v_mul_f32 v23, v23, v17
v_accvgpr_write_b32 a4, v20
v_accvgpr_write_b32 a5, v21
v_accvgpr_write_b32 a6, v22
v_accvgpr_write_b32 a7, v23
v_accvgpr_read_b32 v20, a8
v_accvgpr_read_b32 v21, a9
v_accvgpr_read_b32 v22, a10
v_accvgpr_read_b32 v23, a11
v_mul_f32 v20, v20, v16
v_mul_f32 v21, v21, v16
v_mul_f32 v22, v22, v16
v_mul_f32 v23, v23, v16
v_accvgpr_write_b32 a8, v20
v_accvgpr_write_b32 a9, v21
v_accvgpr_write_b32 a10, v22
v_accvgpr_write_b32 a11, v23
v_accvgpr_read_b32 v20, a12
v_accvgpr_read_b32 v21, a13
v_accvgpr_read_b32 v22, a14
v_accvgpr_read_b32 v23, a15
v_mul_f32 v20, v20, v17
v_mul_f32 v21, v21, v17
v_mul_f32 v22, v22, v17
v_mul_f32 v23, v23, v17
v_accvgpr_write_b32 a12, v20
v_accvgpr_write_b32 a13, v21
v_accvgpr_write_b32 a14, v22
v_accvgpr_write_b32 a15, v23
v_accvgpr_read_b32 v20, a16
v_accvgpr_read_b32 v21, a17
v_accvgpr_read_b32 v22, a18
v_accvgpr_read_b32 v23, a19
v_mul_f32 v20, v20, v16
v_mul_f32 v21, v21, v16
v_mul_f32 v22, v22, v16
v_mul_f32 v23, v23, v16
v_accvgpr_write_b32 a16, v20
v_accvgpr_write_b32 a17, v21
v_accvgpr_write_b32 a18, v22
v_accvgpr_write_b32 a19, v23
v_accvgpr_read_b32 v20, a20
v_accvgpr_read_b32 v21, a21
v_accvgpr_read_b32 v22, a22
v_accvgpr_read_b32 v23, a23
v_mul_f32 v20, v20, v17
v_mul_f32 v21, v21, v17
v_mul_f32 v22, v22, v17
v_mul_f32 v23, v23, v17
v_accvgpr_write_b32 a20, v20
v_accvgpr_write_b32 a21, v21
v_accvgpr_write_b32 a22, v22
v_accvgpr_write_b32 a23, v23
v_accvgpr_read_b32 v20, a24
v_accvgpr_read_b32 v21, a25
v_accvgpr_read_b32 v22, a26
v_accvgpr_read_b32 v23, a27
v_mul_f32 v20, v20, v16
v_mul_f32 v21, v21, v16
v_mul_f32 v22, v22, v16
v_mul_f32 v23, v23, v16
v_accvgpr_write_b32 a24, v20
v_accvgpr_write_b32 a25, v21
v_accvgpr_write_b32 a26, v22
v_accvgpr_write_b32 a27, v23
v_accvgpr_read_b32 v20, a28
v_accvgpr_read_b32 v21, a29
v_accvgpr_read_b32 v22, a30
v_accvgpr_read_b32 v23, a31
v_mul_f32 v20, v20, v17
v_mul_f32 v21, v21, v17
v_mul_f32 v22, v22, v17
v_mul_f32 v23, v23, v17
v_accvgpr_write_b32 a28, v20
v_accvgpr_write_b32 a29, v21
v_accvgpr_write_b32 a30, v22
v_accvgpr_write_b32 a31, v23
v_accvgpr_read_b32 v20, a32
v_accvgpr_read_b32 v21, a33
v_accvgpr_read_b32 v22, a34
v_accvgpr_read_b32 v23, a35
v_mul_f32 v20, v20, v16
v_mul_f32 v21, v21, v16
v_mul_f32 v22, v22, v16
v_mul_f32 v23, v23, v16
v_accvgpr_write_b32 a32, v20
v_accvgpr_write_b32 a33, v21
v_accvgpr_write_b32 a34, v22
v_accvgpr_write_b32 a35, v23
v_accvgpr_read_b32 v20, a36
v_accvgpr_read_b32 v21, a37
v_accvgpr_read_b32 v22, a38
v_accvgpr_read_b32 v23, a39
v_mul_f32 v20, v20, v17
v_mul_f32 v21, v21, v17
v_mul_f32 v22, v22, v17
v_mul_f32 v23, v23, v17
v_accvgpr_write_b32 a36, v20
v_accvgpr_write_b32 a37, v21
v_accvgpr_write_b32 a38, v22
v_accvgpr_write_b32 a39, v23
v_accvgpr_read_b32 v20, a40
v_accvgpr_read_b32 v21, a41
v_accvgpr_read_b32 v22, a42
v_accvgpr_read_b32 v23, a43
v_mul_f32 v20, v20, v16
v_mul_f32 v21, v21, v16
v_mul_f32 v22, v22, v16
v_mul_f32 v23, v23, v16
v_accvgpr_write_b32 a40, v20
v_accvgpr_write_b32 a41, v21
v_accvgpr_write_b32 a42, v22
v_accvgpr_write_b32 a43, v23
v_accvgpr_read_b32 v20, a44
v_accvgpr_read_b32 v21, a45
v_accvgpr_read_b32 v22, a46
v_accvgpr_read_b32 v23, a47
v_mul_f32 v20, v20, v17
v_mul_f32 v21, v21, v17
v_mul_f32 v22, v22, v17
v_mul_f32 v23, v23, v17
v_accvgpr_write_b32 a44, v20
v_accvgpr_write_b32 a45, v21
v_accvgpr_write_b32 a46, v22
v_accvgpr_write_b32 a47, v23
v_accvgpr_read_b32 v20, a48
v_accvgpr_read_b32 v21, a49
v_accvgpr_read_b32 v22, a50
v_accvgpr_read_b32 v23, a51
v_mul_f32 v20, v20, v16
v_mul_f32 v21, v21, v16
v_mul_f32 v22, v22, v16
v_mul_f32 v23, v23, v16
v_accvgpr_write_b32 a48, v20
v_accvgpr_write_b32 a49, v21
v_accvgpr_write_b32 a50, v22
v_accvgpr_write_b32 a51, v23
v_accvgpr_read_b32 v20, a52
v_accvgpr_read_b32 v21, a53
v_accvgpr_read_b32 v22, a54
v_accvgpr_read_b32 v23, a55
v_mul_f32 v20, v20, v17
v_mul_f32 v21, v21, v17
v_mul_f32 v22, v22, v17
v_mul_f32 v23, v23, v17
v_accvgpr_write_b32 a52, v20
v_accvgpr_write_b32 a53, v21
v_accvgpr_write_b32 a54, v22
v_accvgpr_write_b32 a55, v23
v_accvgpr_read_b32 v20, a56
v_accvgpr_read_b32 v21, a57
v_accvgpr_read_b32 v22, a58
v_accvgpr_read_b32 v23, a59
v_mul_f32 v20, v20, v16
v_mul_f32 v21, v21, v16
v_mul_f32 v22, v22, v16
v_mul_f32 v23, v23, v16
v_accvgpr_write_b32 a56, v20
v_accvgpr_write_b32 a57, v21
v_accvgpr_write_b32 a58, v22
v_accvgpr_write_b32 a59, v23
v_accvgpr_read_b32 v20, a60
v_accvgpr_read_b32 v21, a61
v_accvgpr_read_b32 v22, a62
v_accvgpr_read_b32 v23, a63
v_mul_f32 v20, v20, v17
v_mul_f32 v21, v21, v17
v_mul_f32 v22, v22, v17
v_mul_f32 v23, v23, v17
v_accvgpr_write_b32 a60, v20
v_accvgpr_write_b32 a61, v21
v_accvgpr_write_b32 a62, v22
v_accvgpr_write_b32 a63, v23
v_accvgpr_read_b32 v20, a64
v_accvgpr_read_b32 v21, a65
v_accvgpr_read_b32 v22, a66
v_accvgpr_read_b32 v23, a67
v_mul_f32 v20, v20, v16
v_mul_f32 v21, v21, v16
v_mul_f32 v22, v22, v16
v_mul_f32 v23, v23, v16
v_accvgpr_write_b32 a64, v20
v_accvgpr_write_b32 a65, v21
v_accvgpr_write_b32 a66, v22
v_accvgpr_write_b32 a67, v23
v_accvgpr_read_b32 v20, a68
v_accvgpr_read_b32 v21, a69
v_accvgpr_read_b32 v22, a70
v_accvgpr_read_b32 v23, a71
v_mul_f32 v20, v20, v17
v_mul_f32 v21, v21, v17
v_mul_f32 v22, v22, v17
v_mul_f32 v23, v23, v17
v_accvgpr_write_b32 a68, v20
v_accvgpr_write_b32 a69, v21
v_accvgpr_write_b32 a70, v22
v_accvgpr_write_b32 a71, v23
v_accvgpr_read_b32 v20, a72
v_accvgpr_read_b32 v21, a73
v_accvgpr_read_b32 v22, a74
v_accvgpr_read_b32 v23, a75
v_mul_f32 v20, v20, v16
v_mul_f32 v21, v21, v16
v_mul_f32 v22, v22, v16
v_mul_f32 v23, v23, v16
v_accvgpr_write_b32 a72, v20
v_accvgpr_write_b32 a73, v21
v_accvgpr_write_b32 a74, v22
v_accvgpr_write_b32 a75, v23
v_accvgpr_read_b32 v20, a76
v_accvgpr_read_b32 v21, a77
v_accvgpr_read_b32 v22, a78
v_accvgpr_read_b32 v23, a79
v_mul_f32 v20, v20, v17
v_mul_f32 v21, v21, v17
v_mul_f32 v22, v22, v17
v_mul_f32 v23, v23, v17
v_accvgpr_write_b32 a76, v20
v_accvgpr_write_b32 a77, v21
v_accvgpr_write_b32 a78, v22
v_accvgpr_write_b32 a79, v23
v_accvgpr_read_b32 v20, a80
v_accvgpr_read_b32 v21, a81
v_accvgpr_read_b32 v22, a82
v_accvgpr_read_b32 v23, a83
v_mul_f32 v20, v20, v16
v_mul_f32 v21, v21, v16
v_mul_f32 v22, v22, v16
v_mul_f32 v23, v23, v16
v_accvgpr_write_b32 a80, v20
v_accvgpr_write_b32 a81, v21
v_accvgpr_write_b32 a82, v22
v_accvgpr_write_b32 a83, v23
v_accvgpr_read_b32 v20, a84
v_accvgpr_read_b32 v21, a85
v_accvgpr_read_b32 v22, a86
v_accvgpr_read_b32 v23, a87
v_mul_f32 v20, v20, v17
v_mul_f32 v21, v21, v17
v_mul_f32 v22, v22, v17
v_mul_f32 v23, v23, v17
v_accvgpr_write_b32 a84, v20
v_accvgpr_write_b32 a85, v21
v_accvgpr_write_b32 a86, v22
v_accvgpr_write_b32 a87, v23
v_accvgpr_read_b32 v20, a88
v_accvgpr_read_b32 v21, a89
v_accvgpr_read_b32 v22, a90
v_accvgpr_read_b32 v23, a91
v_mul_f32 v20, v20, v16
v_mul_f32 v21, v21, v16
v_mul_f32 v22, v22, v16
v_mul_f32 v23, v23, v16
v_accvgpr_write_b32 a88, v20
v_accvgpr_write_b32 a89, v21
v_accvgpr_write_b32 a90, v22
v_accvgpr_write_b32 a91, v23
v_accvgpr_read_b32 v20, a92
v_accvgpr_read_b32 v21, a93
v_accvgpr_read_b32 v22, a94
v_accvgpr_read_b32 v23, a95
v_mul_f32 v20, v20, v17
v_mul_f32 v21, v21, v17
v_mul_f32 v22, v22, v17
v_mul_f32 v23, v23, v17
v_accvgpr_write_b32 a92, v20
v_accvgpr_write_b32 a93, v21
v_accvgpr_write_b32 a94, v22
v_accvgpr_write_b32 a95, v23
v_accvgpr_read_b32 v20, a96
v_accvgpr_read_b32 v21, a97
v_accvgpr_read_b32 v22, a98
v_accvgpr_read_b32 v23, a99
v_mul_f32 v20, v20, v16
v_mul_f32 v21, v21, v16
v_mul_f32 v22, v22, v16
v_mul_f32 v23, v23, v16
v_accvgpr_write_b32 a96, v20
v_accvgpr_write_b32 a97, v21
v_accvgpr_write_b32 a98, v22
v_accvgpr_write_b32 a99, v23
v_accvgpr_read_b32 v20, a100
v_accvgpr_read_b32 v21, a101
v_accvgpr_read_b32 v22, a102
v_accvgpr_read_b32 v23, a103
v_mul_f32 v20, v20, v17
v_mul_f32 v21, v21, v17
v_mul_f32 v22, v22, v17
v_mul_f32 v23, v23, v17
v_accvgpr_write_b32 a100, v20
v_accvgpr_write_b32 a101, v21
v_accvgpr_write_b32 a102, v22
v_accvgpr_write_b32 a103, v23
v_accvgpr_read_b32 v20, a104
v_accvgpr_read_b32 v21, a105
v_accvgpr_read_b32 v22, a106
v_accvgpr_read_b32 v23, a107
v_mul_f32 v20, v20, v16
v_mul_f32 v21, v21, v16
v_mul_f32 v22, v22, v16
v_mul_f32 v23, v23, v16
v_accvgpr_write_b32 a104, v20
v_accvgpr_write_b32 a105, v21
v_accvgpr_write_b32 a106, v22
v_accvgpr_write_b32 a107, v23
v_accvgpr_read_b32 v20, a108
v_accvgpr_read_b32 v21, a109
v_accvgpr_read_b32 v22, a110
v_accvgpr_read_b32 v23, a111
v_mul_f32 v20, v20, v17
v_mul_f32 v21, v21, v17
v_mul_f32 v22, v22, v17
v_mul_f32 v23, v23, v17
v_accvgpr_write_b32 a108, v20
v_accvgpr_write_b32 a109, v21
v_accvgpr_write_b32 a110, v22
v_accvgpr_write_b32 a111, v23
v_accvgpr_read_b32 v20, a112
v_accvgpr_read_b32 v21, a113
v_accvgpr_read_b32 v22, a114
v_accvgpr_read_b32 v23, a115
v_mul_f32 v20, v20, v16
v_mul_f32 v21, v21, v16
v_mul_f32 v22, v22, v16
v_mul_f32 v23, v23, v16
v_accvgpr_write_b32 a112, v20
v_accvgpr_write_b32 a113, v21
v_accvgpr_write_b32 a114, v22
v_accvgpr_write_b32 a115, v23
v_accvgpr_read_b32 v20, a116
v_accvgpr_read_b32 v21, a117
v_accvgpr_read_b32 v22, a118
v_accvgpr_read_b32 v23, a119
v_mul_f32 v20, v20, v17
v_mul_f32 v21, v21, v17
v_mul_f32 v22, v22, v17
v_mul_f32 v23, v23, v17
v_accvgpr_write_b32 a116, v20
v_accvgpr_write_b32 a117, v21
v_accvgpr_write_b32 a118, v22
v_accvgpr_write_b32 a119, v23
v_accvgpr_read_b32 v20, a120
v_accvgpr_read_b32 v21, a121
v_accvgpr_read_b32 v22, a122
v_accvgpr_read_b32 v23, a123
v_mul_f32 v20, v20, v16
v_mul_f32 v21, v21, v16
v_mul_f32 v22, v22, v16
v_mul_f32 v23, v23, v16
v_accvgpr_write_b32 a120, v20
v_accvgpr_write_b32 a121, v21
v_accvgpr_write_b32 a122, v22
v_accvgpr_write_b32 a123, v23
v_accvgpr_read_b32 v20, a124
v_accvgpr_read_b32 v21, a125
v_accvgpr_read_b32 v22, a126
v_accvgpr_read_b32 v23, a127
v_mul_f32 v20, v20, v17
v_mul_f32 v21, v21, v17
v_mul_f32 v22, v22, v17
v_mul_f32 v23, v23, v17
v_accvgpr_write_b32 a124, v20
v_accvgpr_write_b32 a125, v21
v_accvgpr_write_b32 a126, v22
v_accvgpr_write_b32 a127, v23
v_exp_f32 v16, v64
v_exp_f32 v17, v65
v_exp_f32 v18, v66
v_exp_f32 v19, v67
v_exp_f32 v20, v68
v_exp_f32 v21, v69
v_exp_f32 v22, v70
v_exp_f32 v23, v71
v_exp_f32 v24, v72
v_exp_f32 v25, v73
v_exp_f32 v26, v74
v_exp_f32 v27, v75
v_exp_f32 v28, v76
v_exp_f32 v29, v77
v_exp_f32 v30, v78
v_exp_f32 v31, v79
s_nop 0
v_add_f32 v14, v12, v16
v_add_f32 v14, v14, v17
v_add_f32 v14, v14, v18
v_add_f32 v14, v14, v19
v_add_f32 v14, v14, v20
v_add_f32 v14, v14, v21
v_add_f32 v14, v14, v22
v_add_f32 v14, v14, v23
v_add_f32 v15, v13, v24
v_add_f32 v15, v15, v25
v_add_f32 v15, v15, v26
v_add_f32 v15, v15, v27
v_add_f32 v15, v15, v28
v_add_f32 v15, v15, v29
v_add_f32 v15, v15, v30
v_add_f32 v15, v15, v31
v_cvt_pk_bf16_f32 v40, v16, v17
v_cvt_pk_bf16_f32 v41, v18, v19
v_cvt_pk_bf16_f32 v42, v20, v21
v_cvt_pk_bf16_f32 v43, v22, v23
v_cvt_pk_bf16_f32 v44, v24, v25
v_cvt_pk_bf16_f32 v45, v26, v27
v_cvt_pk_bf16_f32 v46, v28, v29
v_cvt_pk_bf16_f32 v47, v30, v31
s_nop 1
s_branch L_back_o
L_rare_e2:
v_max3_f32 v18, v48, v49, v50
v_max3_f32 v18, v18, v51, v52
v_max3_f32 v18, v18, v53, v54
v_max_f32 v18, v18, v55
v_mov_b32 v19, v18
s_nop 1
v_permlane32_swap_b32 v19, v18
v_max_f32 v18, v18, v19
v_mov_b32 v19, v18
s_nop 1
v_permlane16_swap_b32 v19, v18
v_max_f32 v18, v18, v19
v_ceil_f32 v18, v18
v_max_f32 v18, 0, v18
v_exp_f32 v16, -v18
v_add_f32 v10, v10, v18
v_sub_f32 v248, v248, v18
v_sub_f32 v249, v249, v18
v_sub_f32 v250, v250, v18
v_sub_f32 v251, v251, v18
v_sub_f32 v48, v48, v18
v_sub_f32 v49, v49, v18
v_sub_f32 v50, v50, v18
v_sub_f32 v51, v51, v18
v_sub_f32 v52, v52, v18
v_sub_f32 v53, v53, v18
v_sub_f32 v54, v54, v18
v_sub_f32 v55, v55, v18
v_sub_f32 v64, v64, v18
v_sub_f32 v65, v65, v18
v_sub_f32 v66, v66, v18
v_sub_f32 v67, v67, v18
v_sub_f32 v68, v68, v18
v_sub_f32 v69, v69, v18
v_sub_f32 v70, v70, v18
v_sub_f32 v71, v71, v18
v_mul_f32 v14, v14, v16
v_max3_f32 v18, v56, v57, v58
v_max3_f32 v18, v18, v59, v60
v_max3_f32 v18, v18, v61, v62
v_max_f32 v18, v18, v63
v_mov_b32 v19, v18
s_nop 1
v_permlane32_swap_b32 v19, v18
v_max_f32 v18, v18, v19
v_mov_b32 v19, v18
s_nop 1
v_permlane16_swap_b32 v19, v18
v_max_f32 v18, v18, v19
v_ceil_f32 v18, v18
v_max_f32 v18, 0, v18
v_exp_f32 v17, -v18
v_add_f32 v11, v11, v18
v_sub_f32 v252, v252, v18
v_sub_f32 v253, v253, v18
v_sub_f32 v254, v254, v18
v_sub_f32 v255, v255, v18
v_sub_f32 v56, v56, v18
v_sub_f32 v57, v57, v18
v_sub_f32 v58, v58, v18
v_sub_f32 v59, v59, v18
v_sub_f32 v60, v60, v18
v_sub_f32 v61, v61, v18
v_sub_f32 v62, v62, v18
v_sub_f32 v63, v63, v18
v_sub_f32 v72, v72, v18
v_sub_f32 v73, v73, v18
v_sub_f32 v74, v74, v18
v_sub_f32 v75, v75, v18
v_sub_f32 v76, v76, v18
v_sub_f32 v77, v77, v18
v_sub_f32 v78, v78, v18
v_sub_f32 v79, v79, v18
v_mul_f32 v15, v15, v17
s_nop 7
s_nop 7
v_accvgpr_read_b32 v20, a0
v_accvgpr_read_b32 v21, a1
v_accvgpr_read_b32 v22, a2
v_accvgpr_read_b32 v23, a3
v_mul_f32 v20, v20, v16
v_mul_f32 v21, v21, v16
v_mul_f32 v22, v22, v16
v_mul_f32 v23, v23, v16
v_accvgpr_write_b32 a0, v20
v_accvgpr_write_b32 a1, v21
v_accvgpr_write_b32 a2, v22
v_accvgpr_write_b32 a3, v23
v_accvgpr_read_b32 v20, a4
v_accvgpr_read_b32 v21, a5
v_accvgpr_read_b32 v22, a6
v_accvgpr_read_b32 v23, a7
v_mul_f32 v20, v20, v17
v_mul_f32 v21, v21, v17
v_mul_f32 v22, v22, v17
v_mul_f32 v23, v23, v17
v_accvgpr_write_b32 a4, v20
v_accvgpr_write_b32 a5, v21
v_accvgpr_write_b32 a6, v22
v_accvgpr_write_b32 a7, v23
v_accvgpr_read_b32 v20, a8
v_accvgpr_read_b32 v21, a9
v_accvgpr_read_b32 v22, a10
v_accvgpr_read_b32 v23, a11
v_mul_f32 v20, v20, v16
v_mul_f32 v21, v21, v16
v_mul_f32 v22, v22, v16
v_mul_f32 v23, v23, v16
v_accvgpr_write_b32 a8, v20
v_accvgpr_write_b32 a9, v21
v_accvgpr_write_b32 a10, v22
v_accvgpr_write_b32 a11, v23
v_accvgpr_read_b32 v20, a12
v_accvgpr_read_b32 v21, a13
v_accvgpr_read_b32 v22, a14
v_accvgpr_read_b32 v23, a15
v_mul_f32 v20, v20, v17
v_mul_f32 v21, v21, v17
v_mul_f32 v22, v22, v17
v_mul_f32 v23, v23, v17
v_accvgpr_write_b32 a12, v20
v_accvgpr_write_b32 a13, v21
v_accvgpr_write_b32 a14, v22
v_accvgpr_write_b32 a15, v23
v_accvgpr_read_b32 v20, a16
v_accvgpr_read_b32 v21, a17
v_accvgpr_read_b32 v22, a18
v_accvgpr_read_b32 v23, a19
v_mul_f32 v20, v20, v16
v_mul_f32 v21, v21, v16
v_mul_f32 v22, v22, v16
v_mul_f32 v23, v23, v16
v_accvgpr_write_b32 a16, v20
v_accvgpr_write_b32 a17, v21
v_accvgpr_write_b32 a18, v22
v_accvgpr_write_b32 a19, v23
v_accvgpr_read_b32 v20, a20
v_accvgpr_read_b32 v21, a21
v_accvgpr_read_b32 v22, a22
v_accvgpr_read_b32 v23, a23
v_mul_f32 v20, v20, v17
v_mul_f32 v21, v21, v17
v_mul_f32 v22, v22, v17
v_mul_f32 v23, v23, v17
v_accvgpr_write_b32 a20, v20
v_accvgpr_write_b32 a21, v21
v_accvgpr_write_b32 a22, v22
v_accvgpr_write_b32 a23, v23
v_accvgpr_read_b32 v20, a24
v_accvgpr_read_b32 v21, a25
v_accvgpr_read_b32 v22, a26
v_accvgpr_read_b32 v23, a27
v_mul_f32 v20, v20, v16
v_mul_f32 v21, v21, v16
v_mul_f32 v22, v22, v16
v_mul_f32 v23, v23, v16
v_accvgpr_write_b32 a24, v20
v_accvgpr_write_b32 a25, v21
v_accvgpr_write_b32 a26, v22
v_accvgpr_write_b32 a27, v23
v_accvgpr_read_b32 v20, a28
v_accvgpr_read_b32 v21, a29
v_accvgpr_read_b32 v22, a30
v_accvgpr_read_b32 v23, a31
v_mul_f32 v20, v20, v17
v_mul_f32 v21, v21, v17
v_mul_f32 v22, v22, v17
v_mul_f32 v23, v23, v17
v_accvgpr_write_b32 a28, v20
v_accvgpr_write_b32 a29, v21
v_accvgpr_write_b32 a30, v22
v_accvgpr_write_b32 a31, v23
v_accvgpr_read_b32 v20, a32
v_accvgpr_read_b32 v21, a33
v_accvgpr_read_b32 v22, a34
v_accvgpr_read_b32 v23, a35
v_mul_f32 v20, v20, v16
v_mul_f32 v21, v21, v16
v_mul_f32 v22, v22, v16
v_mul_f32 v23, v23, v16
v_accvgpr_write_b32 a32, v20
v_accvgpr_write_b32 a33, v21
v_accvgpr_write_b32 a34, v22
v_accvgpr_write_b32 a35, v23
v_accvgpr_read_b32 v20, a36
v_accvgpr_read_b32 v21, a37
v_accvgpr_read_b32 v22, a38
v_accvgpr_read_b32 v23, a39
v_mul_f32 v20, v20, v17
v_mul_f32 v21, v21, v17
v_mul_f32 v22, v22, v17
v_mul_f32 v23, v23, v17
v_accvgpr_write_b32 a36, v20
v_accvgpr_write_b32 a37, v21
v_accvgpr_write_b32 a38, v22
v_accvgpr_write_b32 a39, v23
v_accvgpr_read_b32 v20, a40
v_accvgpr_read_b32 v21, a41
v_accvgpr_read_b32 v22, a42
v_accvgpr_read_b32 v23, a43
v_mul_f32 v20, v20, v16
v_mul_f32 v21, v21, v16
v_mul_f32 v22, v22, v16
v_mul_f32 v23, v23, v16
v_accvgpr_write_b32 a40, v20
v_accvgpr_write_b32 a41, v21
v_accvgpr_write_b32 a42, v22
v_accvgpr_write_b32 a43, v23
v_accvgpr_read_b32 v20, a44
v_accvgpr_read_b32 v21, a45
v_accvgpr_read_b32 v22, a46
v_accvgpr_read_b32 v23, a47
v_mul_f32 v20, v20, v17
v_mul_f32 v21, v21, v17
v_mul_f32 v22, v22, v17
v_mul_f32 v23, v23, v17
v_accvgpr_write_b32 a44, v20
v_accvgpr_write_b32 a45, v21
v_accvgpr_write_b32 a46, v22
v_accvgpr_write_b32 a47, v23
v_accvgpr_read_b32 v20, a48
v_accvgpr_read_b32 v21, a49
v_accvgpr_read_b32 v22, a50
v_accvgpr_read_b32 v23, a51
v_mul_f32 v20, v20, v16
v_mul_f32 v21, v21, v16
v_mul_f32 v22, v22, v16
v_mul_f32 v23, v23, v16
v_accvgpr_write_b32 a48, v20
v_accvgpr_write_b32 a49, v21
v_accvgpr_write_b32 a50, v22
v_accvgpr_write_b32 a51, v23
v_accvgpr_read_b32 v20, a52
v_accvgpr_read_b32 v21, a53
v_accvgpr_read_b32 v22, a54
v_accvgpr_read_b32 v23, a55
v_mul_f32 v20, v20, v17
v_mul_f32 v21, v21, v17
v_mul_f32 v22, v22, v17
v_mul_f32 v23, v23, v17
v_accvgpr_write_b32 a52, v20
v_accvgpr_write_b32 a53, v21
v_accvgpr_write_b32 a54, v22
v_accvgpr_write_b32 a55, v23
v_accvgpr_read_b32 v20, a56
v_accvgpr_read_b32 v21, a57
v_accvgpr_read_b32 v22, a58
v_accvgpr_read_b32 v23, a59
v_mul_f32 v20, v20, v16
v_mul_f32 v21, v21, v16
v_mul_f32 v22, v22, v16
v_mul_f32 v23, v23, v16
v_accvgpr_write_b32 a56, v20
v_accvgpr_write_b32 a57, v21
v_accvgpr_write_b32 a58, v22
v_accvgpr_write_b32 a59, v23
v_accvgpr_read_b32 v20, a60
v_accvgpr_read_b32 v21, a61
v_accvgpr_read_b32 v22, a62
v_accvgpr_read_b32 v23, a63
v_mul_f32 v20, v20, v17
v_mul_f32 v21, v21, v17
v_mul_f32 v22, v22, v17
v_mul_f32 v23, v23, v17
v_accvgpr_write_b32 a60, v20
v_accvgpr_write_b32 a61, v21
v_accvgpr_write_b32 a62, v22
v_accvgpr_write_b32 a63, v23
v_accvgpr_read_b32 v20, a64
v_accvgpr_read_b32 v21, a65
v_accvgpr_read_b32 v22, a66
v_accvgpr_read_b32 v23, a67
v_mul_f32 v20, v20, v16
v_mul_f32 v21, v21, v16
v_mul_f32 v22, v22, v16
v_mul_f32 v23, v23, v16
v_accvgpr_write_b32 a64, v20
v_accvgpr_write_b32 a65, v21
v_accvgpr_write_b32 a66, v22
v_accvgpr_write_b32 a67, v23
v_accvgpr_read_b32 v20, a68
v_accvgpr_read_b32 v21, a69
v_accvgpr_read_b32 v22, a70
v_accvgpr_read_b32 v23, a71
v_mul_f32 v20, v20, v17
v_mul_f32 v21, v21, v17
v_mul_f32 v22, v22, v17
v_mul_f32 v23, v23, v17
v_accvgpr_write_b32 a68, v20
v_accvgpr_write_b32 a69, v21
v_accvgpr_write_b32 a70, v22
v_accvgpr_write_b32 a71, v23
v_accvgpr_read_b32 v20, a72
v_accvgpr_read_b32 v21, a73
v_accvgpr_read_b32 v22, a74
v_accvgpr_read_b32 v23, a75
v_mul_f32 v20, v20, v16
v_mul_f32 v21, v21, v16
v_mul_f32 v22, v22, v16
v_mul_f32 v23, v23, v16
v_accvgpr_write_b32 a72, v20
v_accvgpr_write_b32 a73, v21
v_accvgpr_write_b32 a74, v22
v_accvgpr_write_b32 a75, v23
v_accvgpr_read_b32 v20, a76
v_accvgpr_read_b32 v21, a77
v_accvgpr_read_b32 v22, a78
v_accvgpr_read_b32 v23, a79
v_mul_f32 v20, v20, v17
v_mul_f32 v21, v21, v17
v_mul_f32 v22, v22, v17
v_mul_f32 v23, v23, v17
v_accvgpr_write_b32 a76, v20
v_accvgpr_write_b32 a77, v21
v_accvgpr_write_b32 a78, v22
v_accvgpr_write_b32 a79, v23
v_accvgpr_read_b32 v20, a80
v_accvgpr_read_b32 v21, a81
v_accvgpr_read_b32 v22, a82
v_accvgpr_read_b32 v23, a83
v_mul_f32 v20, v20, v16
v_mul_f32 v21, v21, v16
v_mul_f32 v22, v22, v16
v_mul_f32 v23, v23, v16
v_accvgpr_write_b32 a80, v20
v_accvgpr_write_b32 a81, v21
v_accvgpr_write_b32 a82, v22
v_accvgpr_write_b32 a83, v23
v_accvgpr_read_b32 v20, a84
v_accvgpr_read_b32 v21, a85
v_accvgpr_read_b32 v22, a86
v_accvgpr_read_b32 v23, a87
v_mul_f32 v20, v20, v17
v_mul_f32 v21, v21, v17
v_mul_f32 v22, v22, v17
v_mul_f32 v23, v23, v17
v_accvgpr_write_b32 a84, v20
v_accvgpr_write_b32 a85, v21
v_accvgpr_write_b32 a86, v22
v_accvgpr_write_b32 a87, v23
v_accvgpr_read_b32 v20, a88
v_accvgpr_read_b32 v21, a89
v_accvgpr_read_b32 v22, a90
v_accvgpr_read_b32 v23, a91
v_mul_f32 v20, v20, v16
v_mul_f32 v21, v21, v16
v_mul_f32 v22, v22, v16
v_mul_f32 v23, v23, v16
v_accvgpr_write_b32 a88, v20
v_accvgpr_write_b32 a89, v21
v_accvgpr_write_b32 a90, v22
v_accvgpr_write_b32 a91, v23
v_accvgpr_read_b32 v20, a92
v_accvgpr_read_b32 v21, a93
v_accvgpr_read_b32 v22, a94
v_accvgpr_read_b32 v23, a95
v_mul_f32 v20, v20, v17
v_mul_f32 v21, v21, v17
v_mul_f32 v22, v22, v17
v_mul_f32 v23, v23, v17
v_accvgpr_write_b32 a92, v20
v_accvgpr_write_b32 a93, v21
v_accvgpr_write_b32 a94, v22
v_accvgpr_write_b32 a95, v23
v_accvgpr_read_b32 v20, a96
v_accvgpr_read_b32 v21, a97
v_accvgpr_read_b32 v22, a98
v_accvgpr_read_b32 v23, a99
v_mul_f32 v20, v20, v16
v_mul_f32 v21, v21, v16
v_mul_f32 v22, v22, v16
v_mul_f32 v23, v23, v16
v_accvgpr_write_b32 a96, v20
v_accvgpr_write_b32 a97, v21
v_accvgpr_write_b32 a98, v22
v_accvgpr_write_b32 a99, v23
v_accvgpr_read_b32 v20, a100
v_accvgpr_read_b32 v21, a101
v_accvgpr_read_b32 v22, a102
v_accvgpr_read_b32 v23, a103
v_mul_f32 v20, v20, v17
v_mul_f32 v21, v21, v17
v_mul_f32 v22, v22, v17
v_mul_f32 v23, v23, v17
v_accvgpr_write_b32 a100, v20
v_accvgpr_write_b32 a101, v21
v_accvgpr_write_b32 a102, v22
v_accvgpr_write_b32 a103, v23
v_accvgpr_read_b32 v20, a104
v_accvgpr_read_b32 v21, a105
v_accvgpr_read_b32 v22, a106
v_accvgpr_read_b32 v23, a107
v_mul_f32 v20, v20, v16
v_mul_f32 v21, v21, v16
v_mul_f32 v22, v22, v16
v_mul_f32 v23, v23, v16
v_accvgpr_write_b32 a104, v20
v_accvgpr_write_b32 a105, v21
v_accvgpr_write_b32 a106, v22
v_accvgpr_write_b32 a107, v23
v_accvgpr_read_b32 v20, a108
v_accvgpr_read_b32 v21, a109
v_accvgpr_read_b32 v22, a110
v_accvgpr_read_b32 v23, a111
v_mul_f32 v20, v20, v17
v_mul_f32 v21, v21, v17
v_mul_f32 v22, v22, v17
v_mul_f32 v23, v23, v17
v_accvgpr_write_b32 a108, v20
v_accvgpr_write_b32 a109, v21
v_accvgpr_write_b32 a110, v22
v_accvgpr_write_b32 a111, v23
v_accvgpr_read_b32 v20, a112
v_accvgpr_read_b32 v21, a113
v_accvgpr_read_b32 v22, a114
v_accvgpr_read_b32 v23, a115
v_mul_f32 v20, v20, v16
v_mul_f32 v21, v21, v16
v_mul_f32 v22, v22, v16
v_mul_f32 v23, v23, v16
v_accvgpr_write_b32 a112, v20
v_accvgpr_write_b32 a113, v21
v_accvgpr_write_b32 a114, v22
v_accvgpr_write_b32 a115, v23
v_accvgpr_read_b32 v20, a116
v_accvgpr_read_b32 v21, a117
v_accvgpr_read_b32 v22, a118
v_accvgpr_read_b32 v23, a119
v_mul_f32 v20, v20, v17
v_mul_f32 v21, v21, v17
v_mul_f32 v22, v22, v17
v_mul_f32 v23, v23, v17
v_accvgpr_write_b32 a116, v20
v_accvgpr_write_b32 a117, v21
v_accvgpr_write_b32 a118, v22
v_accvgpr_write_b32 a119, v23
v_accvgpr_read_b32 v20, a120
v_accvgpr_read_b32 v21, a121
v_accvgpr_read_b32 v22, a122
v_accvgpr_read_b32 v23, a123
v_mul_f32 v20, v20, v16
v_mul_f32 v21, v21, v16
v_mul_f32 v22, v22, v16
v_mul_f32 v23, v23, v16
v_accvgpr_write_b32 a120, v20
v_accvgpr_write_b32 a121, v21
v_accvgpr_write_b32 a122, v22
v_accvgpr_write_b32 a123, v23
v_accvgpr_read_b32 v20, a124
v_accvgpr_read_b32 v21, a125
v_accvgpr_read_b32 v22, a126
v_accvgpr_read_b32 v23, a127
v_mul_f32 v20, v20, v17
v_mul_f32 v21, v21, v17
v_mul_f32 v22, v22, v17
v_mul_f32 v23, v23, v17
v_accvgpr_write_b32 a124, v20
v_accvgpr_write_b32 a125, v21
v_accvgpr_write_b32 a126, v22
v_accvgpr_write_b32 a127, v23
v_lshlrev_b32 v20, 16, v144
v_and_b32 v21, 0xffff0000, v144
v_mul_f32 v20, v20, v16
v_mul_f32 v21, v21, v16
v_cvt_pk_bf16_f32 v144, v20, v21
v_lshlrev_b32 v20, 16, v145
v_and_b32 v21, 0xffff0000, v145
v_mul_f32 v20, v20, v16
v_mul_f32 v21, v21, v16
v_cvt_pk_bf16_f32 v145, v20, v21
v_lshlrev_b32 v20, 16, v146
v_and_b32 v21, 0xffff0000, v146
v_mul_f32 v20, v20, v16
v_mul_f32 v21, v21, v16
v_cvt_pk_bf16_f32 v146, v20, v21
v_lshlrev_b32 v20, 16, v147
v_and_b32 v21, 0xffff0000, v147
v_mul_f32 v20, v20, v16
v_mul_f32 v21, v21, v16
v_cvt_pk_bf16_f32 v147, v20, v21
v_lshlrev_b32 v20, 16, v148
v_and_b32 v21, 0xffff0000, v148
v_mul_f32 v20, v20, v17
v_mul_f32 v21, v21, v17
v_cvt_pk_bf16_f32 v148, v20, v21
v_lshlrev_b32 v20, 16, v149
v_and_b32 v21, 0xffff0000, v149
v_mul_f32 v20, v20, v17
v_mul_f32 v21, v21, v17
v_cvt_pk_bf16_f32 v149, v20, v21
v_lshlrev_b32 v20, 16, v150
v_and_b32 v21, 0xffff0000, v150
v_mul_f32 v20, v20, v17
v_mul_f32 v21, v21, v17
v_cvt_pk_bf16_f32 v150, v20, v21
v_lshlrev_b32 v20, 16, v151
v_and_b32 v21, 0xffff0000, v151
v_mul_f32 v20, v20, v17
v_mul_f32 v21, v21, v17
v_cvt_pk_bf16_f32 v151, v20, v21
v_lshlrev_b32 v20, 16, v152
v_and_b32 v21, 0xffff0000, v152
v_mul_f32 v20, v20, v16
v_mul_f32 v21, v21, v16
v_cvt_pk_bf16_f32 v152, v20, v21
v_lshlrev_b32 v20, 16, v153
v_and_b32 v21, 0xffff0000, v153
v_mul_f32 v20, v20, v16
v_mul_f32 v21, v21, v16
v_cvt_pk_bf16_f32 v153, v20, v21
v_lshlrev_b32 v20, 16, v154
v_and_b32 v21, 0xffff0000, v154
v_mul_f32 v20, v20, v16
v_mul_f32 v21, v21, v16
v_cvt_pk_bf16_f32 v154, v20, v21
v_lshlrev_b32 v20, 16, v155
v_and_b32 v21, 0xffff0000, v155
v_mul_f32 v20, v20, v16
v_mul_f32 v21, v21, v16
v_cvt_pk_bf16_f32 v155, v20, v21
v_lshlrev_b32 v20, 16, v156
v_and_b32 v21, 0xffff0000, v156
v_mul_f32 v20, v20, v17
v_mul_f32 v21, v21, v17
v_cvt_pk_bf16_f32 v156, v20, v21
v_lshlrev_b32 v20, 16, v157
v_and_b32 v21, 0xffff0000, v157
v_mul_f32 v20, v20, v17
v_mul_f32 v21, v21, v17
v_cvt_pk_bf16_f32 v157, v20, v21
v_lshlrev_b32 v20, 16, v158
v_and_b32 v21, 0xffff0000, v158
v_mul_f32 v20, v20, v17
v_mul_f32 v21, v21, v17
v_cvt_pk_bf16_f32 v158, v20, v21
v_lshlrev_b32 v20, 16, v159
v_and_b32 v21, 0xffff0000, v159
v_mul_f32 v20, v20, v17
v_mul_f32 v21, v21, v17
v_cvt_pk_bf16_f32 v159, v20, v21
v_lshlrev_b32 v20, 16, v160
v_and_b32 v21, 0xffff0000, v160
v_mul_f32 v20, v20, v16
v_mul_f32 v21, v21, v16
v_cvt_pk_bf16_f32 v160, v20, v21
v_lshlrev_b32 v20, 16, v161
v_and_b32 v21, 0xffff0000, v161
v_mul_f32 v20, v20, v16
v_mul_f32 v21, v21, v16
v_cvt_pk_bf16_f32 v161, v20, v21
v_lshlrev_b32 v20, 16, v162
v_and_b32 v21, 0xffff0000, v162
v_mul_f32 v20, v20, v16
v_mul_f32 v21, v21, v16
v_cvt_pk_bf16_f32 v162, v20, v21
v_lshlrev_b32 v20, 16, v163
v_and_b32 v21, 0xffff0000, v163
v_mul_f32 v20, v20, v16
v_mul_f32 v21, v21, v16
v_cvt_pk_bf16_f32 v163, v20, v21
v_lshlrev_b32 v20, 16, v164
v_and_b32 v21, 0xffff0000, v164
v_mul_f32 v20, v20, v17
v_mul_f32 v21, v21, v17
v_cvt_pk_bf16_f32 v164, v20, v21
v_lshlrev_b32 v20, 16, v165
v_and_b32 v21, 0xffff0000, v165
v_mul_f32 v20, v20, v17
v_mul_f32 v21, v21, v17
v_cvt_pk_bf16_f32 v165, v20, v21
v_lshlrev_b32 v20, 16, v166
v_and_b32 v21, 0xffff0000, v166
v_mul_f32 v20, v20, v17
v_mul_f32 v21, v21, v17
v_cvt_pk_bf16_f32 v166, v20, v21
v_lshlrev_b32 v20, 16, v167
v_and_b32 v21, 0xffff0000, v167
v_mul_f32 v20, v20, v17
v_mul_f32 v21, v21, v17
v_cvt_pk_bf16_f32 v167, v20, v21
v_lshlrev_b32 v20, 16, v168
v_and_b32 v21, 0xffff0000, v168
v_mul_f32 v20, v20, v16
v_mul_f32 v21, v21, v16
v_cvt_pk_bf16_f32 v168, v20, v21
v_lshlrev_b32 v20, 16, v169
v_and_b32 v21, 0xffff0000, v169
v_mul_f32 v20, v20, v16
v_mul_f32 v21, v21, v16
v_cvt_pk_bf16_f32 v169, v20, v21
v_lshlrev_b32 v20, 16, v170
v_and_b32 v21, 0xffff0000, v170
v_mul_f32 v20, v20, v16
v_mul_f32 v21, v21, v16
v_cvt_pk_bf16_f32 v170, v20, v21
v_lshlrev_b32 v20, 16, v171
v_and_b32 v21, 0xffff0000, v171
v_mul_f32 v20, v20, v16
v_mul_f32 v21, v21, v16
v_cvt_pk_bf16_f32 v171, v20, v21
v_lshlrev_b32 v20, 16, v172
v_and_b32 v21, 0xffff0000, v172
v_mul_f32 v20, v20, v17
v_mul_f32 v21, v21, v17
v_cvt_pk_bf16_f32 v172, v20, v21
v_lshlrev_b32 v20, 16, v173
v_and_b32 v21, 0xffff0000, v173
v_mul_f32 v20, v20, v17
v_mul_f32 v21, v21, v17
v_cvt_pk_bf16_f32 v173, v20, v21
v_lshlrev_b32 v20, 16, v174
v_and_b32 v21, 0xffff0000, v174
v_mul_f32 v20, v20, v17
v_mul_f32 v21, v21, v17
v_cvt_pk_bf16_f32 v174, v20, v21
v_lshlrev_b32 v20, 16, v175
v_and_b32 v21, 0xffff0000, v175
v_mul_f32 v20, v20, v17
v_mul_f32 v21, v21, v17
v_cvt_pk_bf16_f32 v175, v20, v21
v_lshlrev_b32 v20, 16, v176
v_and_b32 v21, 0xffff0000, v176
v_mul_f32 v20, v20, v16
v_mul_f32 v21, v21, v16
v_cvt_pk_bf16_f32 v176, v20, v21
v_lshlrev_b32 v20, 16, v177
v_and_b32 v21, 0xffff0000, v177
v_mul_f32 v20, v20, v16
v_mul_f32 v21, v21, v16
v_cvt_pk_bf16_f32 v177, v20, v21
v_lshlrev_b32 v20, 16, v178
v_and_b32 v21, 0xffff0000, v178
v_mul_f32 v20, v20, v16
v_mul_f32 v21, v21, v16
v_cvt_pk_bf16_f32 v178, v20, v21
v_lshlrev_b32 v20, 16, v179
v_and_b32 v21, 0xffff0000, v179
v_mul_f32 v20, v20, v16
v_mul_f32 v21, v21, v16
v_cvt_pk_bf16_f32 v179, v20, v21
v_lshlrev_b32 v20, 16, v180
v_and_b32 v21, 0xffff0000, v180
v_mul_f32 v20, v20, v17
v_mul_f32 v21, v21, v17
v_cvt_pk_bf16_f32 v180, v20, v21
v_lshlrev_b32 v20, 16, v181
v_and_b32 v21, 0xffff0000, v181
v_mul_f32 v20, v20, v17
v_mul_f32 v21, v21, v17
v_cvt_pk_bf16_f32 v181, v20, v21
v_lshlrev_b32 v20, 16, v182
v_and_b32 v21, 0xffff0000, v182
v_mul_f32 v20, v20, v17
v_mul_f32 v21, v21, v17
v_cvt_pk_bf16_f32 v182, v20, v21
v_lshlrev_b32 v20, 16, v183
v_and_b32 v21, 0xffff0000, v183
v_mul_f32 v20, v20, v17
v_mul_f32 v21, v21, v17
v_cvt_pk_bf16_f32 v183, v20, v21
v_lshlrev_b32 v20, 16, v184
v_and_b32 v21, 0xffff0000, v184
v_mul_f32 v20, v20, v16
v_mul_f32 v21, v21, v16
v_cvt_pk_bf16_f32 v184, v20, v21
v_lshlrev_b32 v20, 16, v185
v_and_b32 v21, 0xffff0000, v185
v_mul_f32 v20, v20, v16
v_mul_f32 v21, v21, v16
v_cvt_pk_bf16_f32 v185, v20, v21
v_lshlrev_b32 v20, 16, v186
v_and_b32 v21, 0xffff0000, v186
v_mul_f32 v20, v20, v16
v_mul_f32 v21, v21, v16
v_cvt_pk_bf16_f32 v186, v20, v21
v_lshlrev_b32 v20, 16, v187
v_and_b32 v21, 0xffff0000, v187
v_mul_f32 v20, v20, v16
v_mul_f32 v21, v21, v16
v_cvt_pk_bf16_f32 v187, v20, v21
v_lshlrev_b32 v20, 16, v188
v_and_b32 v21, 0xffff0000, v188
v_mul_f32 v20, v20, v17
v_mul_f32 v21, v21, v17
v_cvt_pk_bf16_f32 v188, v20, v21
v_lshlrev_b32 v20, 16, v189
v_and_b32 v21, 0xffff0000, v189
v_mul_f32 v20, v20, v17
v_mul_f32 v21, v21, v17
v_cvt_pk_bf16_f32 v189, v20, v21
v_lshlrev_b32 v20, 16, v190
v_and_b32 v21, 0xffff0000, v190
v_mul_f32 v20, v20, v17
v_mul_f32 v21, v21, v17
v_cvt_pk_bf16_f32 v190, v20, v21
v_lshlrev_b32 v20, 16, v191
v_and_b32 v21, 0xffff0000, v191
v_mul_f32 v20, v20, v17
v_mul_f32 v21, v21, v17
v_cvt_pk_bf16_f32 v191, v20, v21
v_lshlrev_b32 v20, 16, v192
v_and_b32 v21, 0xffff0000, v192
v_mul_f32 v20, v20, v16
v_mul_f32 v21, v21, v16
v_cvt_pk_bf16_f32 v192, v20, v21
v_lshlrev_b32 v20, 16, v193
v_and_b32 v21, 0xffff0000, v193
v_mul_f32 v20, v20, v16
v_mul_f32 v21, v21, v16
v_cvt_pk_bf16_f32 v193, v20, v21
v_lshlrev_b32 v20, 16, v194
v_and_b32 v21, 0xffff0000, v194
v_mul_f32 v20, v20, v16
v_mul_f32 v21, v21, v16
v_cvt_pk_bf16_f32 v194, v20, v21
v_lshlrev_b32 v20, 16, v195
v_and_b32 v21, 0xffff0000, v195
v_mul_f32 v20, v20, v16
v_mul_f32 v21, v21, v16
v_cvt_pk_bf16_f32 v195, v20, v21
v_lshlrev_b32 v20, 16, v196
v_and_b32 v21, 0xffff0000, v196
v_mul_f32 v20, v20, v17
v_mul_f32 v21, v21, v17
v_cvt_pk_bf16_f32 v196, v20, v21
v_lshlrev_b32 v20, 16, v197
v_and_b32 v21, 0xffff0000, v197
v_mul_f32 v20, v20, v17
v_mul_f32 v21, v21, v17
v_cvt_pk_bf16_f32 v197, v20, v21
v_lshlrev_b32 v20, 16, v198
v_and_b32 v21, 0xffff0000, v198
v_mul_f32 v20, v20, v17
v_mul_f32 v21, v21, v17
v_cvt_pk_bf16_f32 v198, v20, v21
v_lshlrev_b32 v20, 16, v199
v_and_b32 v21, 0xffff0000, v199
v_mul_f32 v20, v20, v17
v_mul_f32 v21, v21, v17
v_cvt_pk_bf16_f32 v199, v20, v21
v_lshlrev_b32 v20, 16, v200
v_and_b32 v21, 0xffff0000, v200
v_mul_f32 v20, v20, v16
v_mul_f32 v21, v21, v16
v_cvt_pk_bf16_f32 v200, v20, v21
v_lshlrev_b32 v20, 16, v201
v_and_b32 v21, 0xffff0000, v201
v_mul_f32 v20, v20, v16
v_mul_f32 v21, v21, v16
v_cvt_pk_bf16_f32 v201, v20, v21
v_lshlrev_b32 v20, 16, v202
v_and_b32 v21, 0xffff0000, v202
v_mul_f32 v20, v20, v16
v_mul_f32 v21, v21, v16
v_cvt_pk_bf16_f32 v202, v20, v21
v_lshlrev_b32 v20, 16, v203
v_and_b32 v21, 0xffff0000, v203
v_mul_f32 v20, v20, v16
v_mul_f32 v21, v21, v16
v_cvt_pk_bf16_f32 v203, v20, v21
v_lshlrev_b32 v20, 16, v204
v_and_b32 v21, 0xffff0000, v204
v_mul_f32 v20, v20, v17
v_mul_f32 v21, v21, v17
v_cvt_pk_bf16_f32 v204, v20, v21
v_lshlrev_b32 v20, 16, v205
v_and_b32 v21, 0xffff0000, v205
v_mul_f32 v20, v20, v17
v_mul_f32 v21, v21, v17
v_cvt_pk_bf16_f32 v205, v20, v21
v_lshlrev_b32 v20, 16, v206
v_and_b32 v21, 0xffff0000, v206
v_mul_f32 v20, v20, v17
v_mul_f32 v21, v21, v17
v_cvt_pk_bf16_f32 v206, v20, v21
v_lshlrev_b32 v20, 16, v207
v_and_b32 v21, 0xffff0000, v207
v_mul_f32 v20, v20, v17
v_mul_f32 v21, v21, v17
v_cvt_pk_bf16_f32 v207, v20, v21
v_exp_f32 v16, v48
v_exp_f32 v17, v49
v_exp_f32 v18, v50
v_exp_f32 v19, v51
v_exp_f32 v20, v52
v_exp_f32 v21, v53
v_exp_f32 v22, v54
v_exp_f32 v23, v55
v_exp_f32 v24, v56
v_exp_f32 v25, v57
v_exp_f32 v26, v58
v_exp_f32 v27, v59
v_exp_f32 v28, v60
v_exp_f32 v29, v61
v_exp_f32 v30, v62
v_exp_f32 v31, v63
s_nop 0
v_add_f32 v12, v14, v16
v_add_f32 v12, v12, v17
v_add_f32 v12, v12, v18
v_add_f32 v12, v12, v19
v_add_f32 v12, v12, v20
v_add_f32 v12, v12, v21
v_add_f32 v12, v12, v22
v_add_f32 v12, v12, v23
v_add_f32 v13, v15, v24
v_add_f32 v13, v13, v25
v_add_f32 v13, v13, v26
v_add_f32 v13, v13, v27
v_add_f32 v13, v13, v28
v_add_f32 v13, v13, v29
v_add_f32 v13, v13, v30
v_add_f32 v13, v13, v31
v_cvt_pk_bf16_f32 v32, v16, v17
v_cvt_pk_bf16_f32 v33, v18, v19
v_cvt_pk_bf16_f32 v34, v20, v21
v_cvt_pk_bf16_f32 v35, v22, v23
v_cvt_pk_bf16_f32 v36, v24, v25
v_cvt_pk_bf16_f32 v37, v26, v27
v_cvt_pk_bf16_f32 v38, v28, v29
v_cvt_pk_bf16_f32 v39, v30, v31
s_nop 1
s_branch L_back_e2
L_rare_o2:
v_max3_f32 v18, v64, v65, v66
v_max3_f32 v18, v18, v67, v68
v_max3_f32 v18, v18, v69, v70
v_max_f32 v18, v18, v71
v_mov_b32 v19, v18
s_nop 1
v_permlane32_swap_b32 v19, v18
v_max_f32 v18, v18, v19
v_mov_b32 v19, v18
s_nop 1
v_permlane16_swap_b32 v19, v18
v_max_f32 v18, v18, v19
v_ceil_f32 v18, v18
v_max_f32 v18, 0, v18
v_exp_f32 v16, -v18
v_add_f32 v10, v10, v18
v_sub_f32 v248, v248, v18
v_sub_f32 v249, v249, v18
v_sub_f32 v250, v250, v18
v_sub_f32 v251, v251, v18
v_sub_f32 v64, v64, v18
v_sub_f32 v65, v65, v18
v_sub_f32 v66, v66, v18
v_sub_f32 v67, v67, v18
v_sub_f32 v68, v68, v18
v_sub_f32 v69, v69, v18
v_sub_f32 v70, v70, v18
v_sub_f32 v71, v71, v18
v_sub_f32 v48, v48, v18
v_sub_f32 v49, v49, v18
v_sub_f32 v50, v50, v18
v_sub_f32 v51, v51, v18
v_sub_f32 v52, v52, v18
v_sub_f32 v53, v53, v18
v_sub_f32 v54, v54, v18
v_sub_f32 v55, v55, v18
v_mul_f32 v12, v12, v16
v_max3_f32 v18, v72, v73, v74
v_max3_f32 v18, v18, v75, v76
v_max3_f32 v18, v18, v77, v78
v_max_f32 v18, v18, v79
v_mov_b32 v19, v18
s_nop 1
v_permlane32_swap_b32 v19, v18
v_max_f32 v18, v18, v19
v_mov_b32 v19, v18
s_nop 1
v_permlane16_swap_b32 v19, v18
v_max_f32 v18, v18, v19
v_ceil_f32 v18, v18
v_max_f32 v18, 0, v18
v_exp_f32 v17, -v18
v_add_f32 v11, v11, v18
v_sub_f32 v252, v252, v18
v_sub_f32 v253, v253, v18
v_sub_f32 v254, v254, v18
v_sub_f32 v255, v255, v18
v_sub_f32 v72, v72, v18
v_sub_f32 v73, v73, v18
v_sub_f32 v74, v74, v18
v_sub_f32 v75, v75, v18
v_sub_f32 v76, v76, v18
v_sub_f32 v77, v77, v18
v_sub_f32 v78, v78, v18
v_sub_f32 v79, v79, v18
v_sub_f32 v56, v56, v18
v_sub_f32 v57, v57, v18
v_sub_f32 v58, v58, v18
v_sub_f32 v59, v59, v18
v_sub_f32 v60, v60, v18
v_sub_f32 v61, v61, v18
v_sub_f32 v62, v62, v18
v_sub_f32 v63, v63, v18
v_mul_f32 v13, v13, v17
s_nop 7
s_nop 7
v_accvgpr_read_b32 v20, a0
v_accvgpr_read_b32 v21, a1
v_accvgpr_read_b32 v22, a2
v_accvgpr_read_b32 v23, a3
v_mul_f32 v20, v20, v16
v_mul_f32 v21, v21, v16
v_mul_f32 v22, v22, v16
v_mul_f32 v23, v23, v16
v_accvgpr_write_b32 a0, v20
v_accvgpr_write_b32 a1, v21
v_accvgpr_write_b32 a2, v22
v_accvgpr_write_b32 a3, v23
v_accvgpr_read_b32 v20, a4
v_accvgpr_read_b32 v21, a5
v_accvgpr_read_b32 v22, a6
v_accvgpr_read_b32 v23, a7
v_mul_f32 v20, v20, v17
v_mul_f32 v21, v21, v17
v_mul_f32 v22, v22, v17
v_mul_f32 v23, v23, v17
v_accvgpr_write_b32 a4, v20
v_accvgpr_write_b32 a5, v21
v_accvgpr_write_b32 a6, v22
v_accvgpr_write_b32 a7, v23
v_accvgpr_read_b32 v20, a8
v_accvgpr_read_b32 v21, a9
v_accvgpr_read_b32 v22, a10
v_accvgpr_read_b32 v23, a11
v_mul_f32 v20, v20, v16
v_mul_f32 v21, v21, v16
v_mul_f32 v22, v22, v16
v_mul_f32 v23, v23, v16
v_accvgpr_write_b32 a8, v20
v_accvgpr_write_b32 a9, v21
v_accvgpr_write_b32 a10, v22
v_accvgpr_write_b32 a11, v23
v_accvgpr_read_b32 v20, a12
v_accvgpr_read_b32 v21, a13
v_accvgpr_read_b32 v22, a14
v_accvgpr_read_b32 v23, a15
v_mul_f32 v20, v20, v17
v_mul_f32 v21, v21, v17
v_mul_f32 v22, v22, v17
v_mul_f32 v23, v23, v17
v_accvgpr_write_b32 a12, v20
v_accvgpr_write_b32 a13, v21
v_accvgpr_write_b32 a14, v22
v_accvgpr_write_b32 a15, v23
v_accvgpr_read_b32 v20, a16
v_accvgpr_read_b32 v21, a17
v_accvgpr_read_b32 v22, a18
v_accvgpr_read_b32 v23, a19
v_mul_f32 v20, v20, v16
v_mul_f32 v21, v21, v16
v_mul_f32 v22, v22, v16
v_mul_f32 v23, v23, v16
v_accvgpr_write_b32 a16, v20
v_accvgpr_write_b32 a17, v21
v_accvgpr_write_b32 a18, v22
v_accvgpr_write_b32 a19, v23
v_accvgpr_read_b32 v20, a20
v_accvgpr_read_b32 v21, a21
v_accvgpr_read_b32 v22, a22
v_accvgpr_read_b32 v23, a23
v_mul_f32 v20, v20, v17
v_mul_f32 v21, v21, v17
v_mul_f32 v22, v22, v17
v_mul_f32 v23, v23, v17
v_accvgpr_write_b32 a20, v20
v_accvgpr_write_b32 a21, v21
v_accvgpr_write_b32 a22, v22
v_accvgpr_write_b32 a23, v23
v_accvgpr_read_b32 v20, a24
v_accvgpr_read_b32 v21, a25
v_accvgpr_read_b32 v22, a26
v_accvgpr_read_b32 v23, a27
v_mul_f32 v20, v20, v16
v_mul_f32 v21, v21, v16
v_mul_f32 v22, v22, v16
v_mul_f32 v23, v23, v16
v_accvgpr_write_b32 a24, v20
v_accvgpr_write_b32 a25, v21
v_accvgpr_write_b32 a26, v22
v_accvgpr_write_b32 a27, v23
v_accvgpr_read_b32 v20, a28
v_accvgpr_read_b32 v21, a29
v_accvgpr_read_b32 v22, a30
v_accvgpr_read_b32 v23, a31
v_mul_f32 v20, v20, v17
v_mul_f32 v21, v21, v17
v_mul_f32 v22, v22, v17
v_mul_f32 v23, v23, v17
v_accvgpr_write_b32 a28, v20
v_accvgpr_write_b32 a29, v21
v_accvgpr_write_b32 a30, v22
v_accvgpr_write_b32 a31, v23
v_accvgpr_read_b32 v20, a32
v_accvgpr_read_b32 v21, a33
v_accvgpr_read_b32 v22, a34
v_accvgpr_read_b32 v23, a35
v_mul_f32 v20, v20, v16
v_mul_f32 v21, v21, v16
v_mul_f32 v22, v22, v16
v_mul_f32 v23, v23, v16
v_accvgpr_write_b32 a32, v20
v_accvgpr_write_b32 a33, v21
v_accvgpr_write_b32 a34, v22
v_accvgpr_write_b32 a35, v23
v_accvgpr_read_b32 v20, a36
v_accvgpr_read_b32 v21, a37
v_accvgpr_read_b32 v22, a38
v_accvgpr_read_b32 v23, a39
v_mul_f32 v20, v20, v17
v_mul_f32 v21, v21, v17
v_mul_f32 v22, v22, v17
v_mul_f32 v23, v23, v17
v_accvgpr_write_b32 a36, v20
v_accvgpr_write_b32 a37, v21
v_accvgpr_write_b32 a38, v22
v_accvgpr_write_b32 a39, v23
v_accvgpr_read_b32 v20, a40
v_accvgpr_read_b32 v21, a41
v_accvgpr_read_b32 v22, a42
v_accvgpr_read_b32 v23, a43
v_mul_f32 v20, v20, v16
v_mul_f32 v21, v21, v16
v_mul_f32 v22, v22, v16
v_mul_f32 v23, v23, v16
v_accvgpr_write_b32 a40, v20
v_accvgpr_write_b32 a41, v21
v_accvgpr_write_b32 a42, v22
v_accvgpr_write_b32 a43, v23
v_accvgpr_read_b32 v20, a44
v_accvgpr_read_b32 v21, a45
v_accvgpr_read_b32 v22, a46
v_accvgpr_read_b32 v23, a47
v_mul_f32 v20, v20, v17
v_mul_f32 v21, v21, v17
v_mul_f32 v22, v22, v17
v_mul_f32 v23, v23, v17
v_accvgpr_write_b32 a44, v20
v_accvgpr_write_b32 a45, v21
v_accvgpr_write_b32 a46, v22
v_accvgpr_write_b32 a47, v23
v_accvgpr_read_b32 v20, a48
v_accvgpr_read_b32 v21, a49
v_accvgpr_read_b32 v22, a50
v_accvgpr_read_b32 v23, a51
v_mul_f32 v20, v20, v16
v_mul_f32 v21, v21, v16
v_mul_f32 v22, v22, v16
v_mul_f32 v23, v23, v16
v_accvgpr_write_b32 a48, v20
v_accvgpr_write_b32 a49, v21
v_accvgpr_write_b32 a50, v22
v_accvgpr_write_b32 a51, v23
v_accvgpr_read_b32 v20, a52
v_accvgpr_read_b32 v21, a53
v_accvgpr_read_b32 v22, a54
v_accvgpr_read_b32 v23, a55
v_mul_f32 v20, v20, v17
v_mul_f32 v21, v21, v17
v_mul_f32 v22, v22, v17
v_mul_f32 v23, v23, v17
v_accvgpr_write_b32 a52, v20
v_accvgpr_write_b32 a53, v21
v_accvgpr_write_b32 a54, v22
v_accvgpr_write_b32 a55, v23
v_accvgpr_read_b32 v20, a56
v_accvgpr_read_b32 v21, a57
v_accvgpr_read_b32 v22, a58
v_accvgpr_read_b32 v23, a59
v_mul_f32 v20, v20, v16
v_mul_f32 v21, v21, v16
v_mul_f32 v22, v22, v16
v_mul_f32 v23, v23, v16
v_accvgpr_write_b32 a56, v20
v_accvgpr_write_b32 a57, v21
v_accvgpr_write_b32 a58, v22
v_accvgpr_write_b32 a59, v23
v_accvgpr_read_b32 v20, a60
v_accvgpr_read_b32 v21, a61
v_accvgpr_read_b32 v22, a62
v_accvgpr_read_b32 v23, a63
v_mul_f32 v20, v20, v17
v_mul_f32 v21, v21, v17
v_mul_f32 v22, v22, v17
v_mul_f32 v23, v23, v17
v_accvgpr_write_b32 a60, v20
v_accvgpr_write_b32 a61, v21
v_accvgpr_write_b32 a62, v22
v_accvgpr_write_b32 a63, v23
v_accvgpr_read_b32 v20, a64
v_accvgpr_read_b32 v21, a65
v_accvgpr_read_b32 v22, a66
v_accvgpr_read_b32 v23, a67
v_mul_f32 v20, v20, v16
v_mul_f32 v21, v21, v16
v_mul_f32 v22, v22, v16
v_mul_f32 v23, v23, v16
v_accvgpr_write_b32 a64, v20
v_accvgpr_write_b32 a65, v21
v_accvgpr_write_b32 a66, v22
v_accvgpr_write_b32 a67, v23
v_accvgpr_read_b32 v20, a68
v_accvgpr_read_b32 v21, a69
v_accvgpr_read_b32 v22, a70
v_accvgpr_read_b32 v23, a71
v_mul_f32 v20, v20, v17
v_mul_f32 v21, v21, v17
v_mul_f32 v22, v22, v17
v_mul_f32 v23, v23, v17
v_accvgpr_write_b32 a68, v20
v_accvgpr_write_b32 a69, v21
v_accvgpr_write_b32 a70, v22
v_accvgpr_write_b32 a71, v23
v_accvgpr_read_b32 v20, a72
v_accvgpr_read_b32 v21, a73
v_accvgpr_read_b32 v22, a74
v_accvgpr_read_b32 v23, a75
v_mul_f32 v20, v20, v16
v_mul_f32 v21, v21, v16
v_mul_f32 v22, v22, v16
v_mul_f32 v23, v23, v16
v_accvgpr_write_b32 a72, v20
v_accvgpr_write_b32 a73, v21
v_accvgpr_write_b32 a74, v22
v_accvgpr_write_b32 a75, v23
v_accvgpr_read_b32 v20, a76
v_accvgpr_read_b32 v21, a77
v_accvgpr_read_b32 v22, a78
v_accvgpr_read_b32 v23, a79
v_mul_f32 v20, v20, v17
v_mul_f32 v21, v21, v17
v_mul_f32 v22, v22, v17
v_mul_f32 v23, v23, v17
v_accvgpr_write_b32 a76, v20
v_accvgpr_write_b32 a77, v21
v_accvgpr_write_b32 a78, v22
v_accvgpr_write_b32 a79, v23
v_accvgpr_read_b32 v20, a80
v_accvgpr_read_b32 v21, a81
v_accvgpr_read_b32 v22, a82
v_accvgpr_read_b32 v23, a83
v_mul_f32 v20, v20, v16
v_mul_f32 v21, v21, v16
v_mul_f32 v22, v22, v16
v_mul_f32 v23, v23, v16
v_accvgpr_write_b32 a80, v20
v_accvgpr_write_b32 a81, v21
v_accvgpr_write_b32 a82, v22
v_accvgpr_write_b32 a83, v23
v_accvgpr_read_b32 v20, a84
v_accvgpr_read_b32 v21, a85
v_accvgpr_read_b32 v22, a86
v_accvgpr_read_b32 v23, a87
v_mul_f32 v20, v20, v17
v_mul_f32 v21, v21, v17
v_mul_f32 v22, v22, v17
v_mul_f32 v23, v23, v17
v_accvgpr_write_b32 a84, v20
v_accvgpr_write_b32 a85, v21
v_accvgpr_write_b32 a86, v22
v_accvgpr_write_b32 a87, v23
v_accvgpr_read_b32 v20, a88
v_accvgpr_read_b32 v21, a89
v_accvgpr_read_b32 v22, a90
v_accvgpr_read_b32 v23, a91
v_mul_f32 v20, v20, v16
v_mul_f32 v21, v21, v16
v_mul_f32 v22, v22, v16
v_mul_f32 v23, v23, v16
v_accvgpr_write_b32 a88, v20
v_accvgpr_write_b32 a89, v21
v_accvgpr_write_b32 a90, v22
v_accvgpr_write_b32 a91, v23
v_accvgpr_read_b32 v20, a92
v_accvgpr_read_b32 v21, a93
v_accvgpr_read_b32 v22, a94
v_accvgpr_read_b32 v23, a95
v_mul_f32 v20, v20, v17
v_mul_f32 v21, v21, v17
v_mul_f32 v22, v22, v17
v_mul_f32 v23, v23, v17
v_accvgpr_write_b32 a92, v20
v_accvgpr_write_b32 a93, v21
v_accvgpr_write_b32 a94, v22
v_accvgpr_write_b32 a95, v23
v_accvgpr_read_b32 v20, a96
v_accvgpr_read_b32 v21, a97
v_accvgpr_read_b32 v22, a98
v_accvgpr_read_b32 v23, a99
v_mul_f32 v20, v20, v16
v_mul_f32 v21, v21, v16
v_mul_f32 v22, v22, v16
v_mul_f32 v23, v23, v16
v_accvgpr_write_b32 a96, v20
v_accvgpr_write_b32 a97, v21
v_accvgpr_write_b32 a98, v22
v_accvgpr_write_b32 a99, v23
v_accvgpr_read_b32 v20, a100
v_accvgpr_read_b32 v21, a101
v_accvgpr_read_b32 v22, a102
v_accvgpr_read_b32 v23, a103
v_mul_f32 v20, v20, v17
v_mul_f32 v21, v21, v17
v_mul_f32 v22, v22, v17
v_mul_f32 v23, v23, v17
v_accvgpr_write_b32 a100, v20
v_accvgpr_write_b32 a101, v21
v_accvgpr_write_b32 a102, v22
v_accvgpr_write_b32 a103, v23
v_accvgpr_read_b32 v20, a104
v_accvgpr_read_b32 v21, a105
v_accvgpr_read_b32 v22, a106
v_accvgpr_read_b32 v23, a107
v_mul_f32 v20, v20, v16
v_mul_f32 v21, v21, v16
v_mul_f32 v22, v22, v16
v_mul_f32 v23, v23, v16
v_accvgpr_write_b32 a104, v20
v_accvgpr_write_b32 a105, v21
v_accvgpr_write_b32 a106, v22
v_accvgpr_write_b32 a107, v23
v_accvgpr_read_b32 v20, a108
v_accvgpr_read_b32 v21, a109
v_accvgpr_read_b32 v22, a110
v_accvgpr_read_b32 v23, a111
v_mul_f32 v20, v20, v17
v_mul_f32 v21, v21, v17
v_mul_f32 v22, v22, v17
v_mul_f32 v23, v23, v17
v_accvgpr_write_b32 a108, v20
v_accvgpr_write_b32 a109, v21
v_accvgpr_write_b32 a110, v22
v_accvgpr_write_b32 a111, v23
v_accvgpr_read_b32 v20, a112
v_accvgpr_read_b32 v21, a113
v_accvgpr_read_b32 v22, a114
v_accvgpr_read_b32 v23, a115
v_mul_f32 v20, v20, v16
v_mul_f32 v21, v21, v16
v_mul_f32 v22, v22, v16
v_mul_f32 v23, v23, v16
v_accvgpr_write_b32 a112, v20
v_accvgpr_write_b32 a113, v21
v_accvgpr_write_b32 a114, v22
v_accvgpr_write_b32 a115, v23
v_accvgpr_read_b32 v20, a116
v_accvgpr_read_b32 v21, a117
v_accvgpr_read_b32 v22, a118
v_accvgpr_read_b32 v23, a119
v_mul_f32 v20, v20, v17
v_mul_f32 v21, v21, v17
v_mul_f32 v22, v22, v17
v_mul_f32 v23, v23, v17
v_accvgpr_write_b32 a116, v20
v_accvgpr_write_b32 a117, v21
v_accvgpr_write_b32 a118, v22
v_accvgpr_write_b32 a119, v23
v_accvgpr_read_b32 v20, a120
v_accvgpr_read_b32 v21, a121
v_accvgpr_read_b32 v22, a122
v_accvgpr_read_b32 v23, a123
v_mul_f32 v20, v20, v16
v_mul_f32 v21, v21, v16
v_mul_f32 v22, v22, v16
v_mul_f32 v23, v23, v16
v_accvgpr_write_b32 a120, v20
v_accvgpr_write_b32 a121, v21
v_accvgpr_write_b32 a122, v22
v_accvgpr_write_b32 a123, v23
v_accvgpr_read_b32 v20, a124
v_accvgpr_read_b32 v21, a125
v_accvgpr_read_b32 v22, a126
v_accvgpr_read_b32 v23, a127
v_mul_f32 v20, v20, v17
v_mul_f32 v21, v21, v17
v_mul_f32 v22, v22, v17
v_mul_f32 v23, v23, v17
v_accvgpr_write_b32 a124, v20
v_accvgpr_write_b32 a125, v21
v_accvgpr_write_b32 a126, v22
v_accvgpr_write_b32 a127, v23
v_lshlrev_b32 v20, 16, v144
v_and_b32 v21, 0xffff0000, v144
v_mul_f32 v20, v20, v16
v_mul_f32 v21, v21, v16
v_cvt_pk_bf16_f32 v144, v20, v21
v_lshlrev_b32 v20, 16, v145
v_and_b32 v21, 0xffff0000, v145
v_mul_f32 v20, v20, v16
v_mul_f32 v21, v21, v16
v_cvt_pk_bf16_f32 v145, v20, v21
v_lshlrev_b32 v20, 16, v146
v_and_b32 v21, 0xffff0000, v146
v_mul_f32 v20, v20, v16
v_mul_f32 v21, v21, v16
v_cvt_pk_bf16_f32 v146, v20, v21
v_lshlrev_b32 v20, 16, v147
v_and_b32 v21, 0xffff0000, v147
v_mul_f32 v20, v20, v16
v_mul_f32 v21, v21, v16
v_cvt_pk_bf16_f32 v147, v20, v21
v_lshlrev_b32 v20, 16, v148
v_and_b32 v21, 0xffff0000, v148
v_mul_f32 v20, v20, v17
v_mul_f32 v21, v21, v17
v_cvt_pk_bf16_f32 v148, v20, v21
v_lshlrev_b32 v20, 16, v149
v_and_b32 v21, 0xffff0000, v149
v_mul_f32 v20, v20, v17
v_mul_f32 v21, v21, v17
v_cvt_pk_bf16_f32 v149, v20, v21
v_lshlrev_b32 v20, 16, v150
v_and_b32 v21, 0xffff0000, v150
v_mul_f32 v20, v20, v17
v_mul_f32 v21, v21, v17
v_cvt_pk_bf16_f32 v150, v20, v21
v_lshlrev_b32 v20, 16, v151
v_and_b32 v21, 0xffff0000, v151
v_mul_f32 v20, v20, v17
v_mul_f32 v21, v21, v17
v_cvt_pk_bf16_f32 v151, v20, v21
v_lshlrev_b32 v20, 16, v152
v_and_b32 v21, 0xffff0000, v152
v_mul_f32 v20, v20, v16
v_mul_f32 v21, v21, v16
v_cvt_pk_bf16_f32 v152, v20, v21
v_lshlrev_b32 v20, 16, v153
v_and_b32 v21, 0xffff0000, v153
v_mul_f32 v20, v20, v16
v_mul_f32 v21, v21, v16
v_cvt_pk_bf16_f32 v153, v20, v21
v_lshlrev_b32 v20, 16, v154
v_and_b32 v21, 0xffff0000, v154
v_mul_f32 v20, v20, v16
v_mul_f32 v21, v21, v16
v_cvt_pk_bf16_f32 v154, v20, v21
v_lshlrev_b32 v20, 16, v155
v_and_b32 v21, 0xffff0000, v155
v_mul_f32 v20, v20, v16
v_mul_f32 v21, v21, v16
v_cvt_pk_bf16_f32 v155, v20, v21
v_lshlrev_b32 v20, 16, v156
v_and_b32 v21, 0xffff0000, v156
v_mul_f32 v20, v20, v17
v_mul_f32 v21, v21, v17
v_cvt_pk_bf16_f32 v156, v20, v21
v_lshlrev_b32 v20, 16, v157
v_and_b32 v21, 0xffff0000, v157
v_mul_f32 v20, v20, v17
v_mul_f32 v21, v21, v17
v_cvt_pk_bf16_f32 v157, v20, v21
v_lshlrev_b32 v20, 16, v158
v_and_b32 v21, 0xffff0000, v158
v_mul_f32 v20, v20, v17
v_mul_f32 v21, v21, v17
v_cvt_pk_bf16_f32 v158, v20, v21
v_lshlrev_b32 v20, 16, v159
v_and_b32 v21, 0xffff0000, v159
v_mul_f32 v20, v20, v17
v_mul_f32 v21, v21, v17
v_cvt_pk_bf16_f32 v159, v20, v21
v_lshlrev_b32 v20, 16, v160
v_and_b32 v21, 0xffff0000, v160
v_mul_f32 v20, v20, v16
v_mul_f32 v21, v21, v16
v_cvt_pk_bf16_f32 v160, v20, v21
v_lshlrev_b32 v20, 16, v161
v_and_b32 v21, 0xffff0000, v161
v_mul_f32 v20, v20, v16
v_mul_f32 v21, v21, v16
v_cvt_pk_bf16_f32 v161, v20, v21
v_lshlrev_b32 v20, 16, v162
v_and_b32 v21, 0xffff0000, v162
v_mul_f32 v20, v20, v16
v_mul_f32 v21, v21, v16
v_cvt_pk_bf16_f32 v162, v20, v21
v_lshlrev_b32 v20, 16, v163
v_and_b32 v21, 0xffff0000, v163
v_mul_f32 v20, v20, v16
v_mul_f32 v21, v21, v16
v_cvt_pk_bf16_f32 v163, v20, v21
v_lshlrev_b32 v20, 16, v164
v_and_b32 v21, 0xffff0000, v164
v_mul_f32 v20, v20, v17
v_mul_f32 v21, v21, v17
v_cvt_pk_bf16_f32 v164, v20, v21
v_lshlrev_b32 v20, 16, v165
v_and_b32 v21, 0xffff0000, v165
v_mul_f32 v20, v20, v17
v_mul_f32 v21, v21, v17
v_cvt_pk_bf16_f32 v165, v20, v21
v_lshlrev_b32 v20, 16, v166
v_and_b32 v21, 0xffff0000, v166
v_mul_f32 v20, v20, v17
v_mul_f32 v21, v21, v17
v_cvt_pk_bf16_f32 v166, v20, v21
v_lshlrev_b32 v20, 16, v167
v_and_b32 v21, 0xffff0000, v167
v_mul_f32 v20, v20, v17
v_mul_f32 v21, v21, v17
v_cvt_pk_bf16_f32 v167, v20, v21
v_lshlrev_b32 v20, 16, v168
v_and_b32 v21, 0xffff0000, v168
v_mul_f32 v20, v20, v16
v_mul_f32 v21, v21, v16
v_cvt_pk_bf16_f32 v168, v20, v21
v_lshlrev_b32 v20, 16, v169
v_and_b32 v21, 0xffff0000, v169
v_mul_f32 v20, v20, v16
v_mul_f32 v21, v21, v16
v_cvt_pk_bf16_f32 v169, v20, v21
v_lshlrev_b32 v20, 16, v170
v_and_b32 v21, 0xffff0000, v170
v_mul_f32 v20, v20, v16
v_mul_f32 v21, v21, v16
v_cvt_pk_bf16_f32 v170, v20, v21
v_lshlrev_b32 v20, 16, v171
v_and_b32 v21, 0xffff0000, v171
v_mul_f32 v20, v20, v16
v_mul_f32 v21, v21, v16
v_cvt_pk_bf16_f32 v171, v20, v21
v_lshlrev_b32 v20, 16, v172
v_and_b32 v21, 0xffff0000, v172
v_mul_f32 v20, v20, v17
v_mul_f32 v21, v21, v17
v_cvt_pk_bf16_f32 v172, v20, v21
v_lshlrev_b32 v20, 16, v173
v_and_b32 v21, 0xffff0000, v173
v_mul_f32 v20, v20, v17
v_mul_f32 v21, v21, v17
v_cvt_pk_bf16_f32 v173, v20, v21
v_lshlrev_b32 v20, 16, v174
v_and_b32 v21, 0xffff0000, v174
v_mul_f32 v20, v20, v17
v_mul_f32 v21, v21, v17
v_cvt_pk_bf16_f32 v174, v20, v21
v_lshlrev_b32 v20, 16, v175
v_and_b32 v21, 0xffff0000, v175
v_mul_f32 v20, v20, v17
v_mul_f32 v21, v21, v17
v_cvt_pk_bf16_f32 v175, v20, v21
v_lshlrev_b32 v20, 16, v176
v_and_b32 v21, 0xffff0000, v176
v_mul_f32 v20, v20, v16
v_mul_f32 v21, v21, v16
v_cvt_pk_bf16_f32 v176, v20, v21
v_lshlrev_b32 v20, 16, v177
v_and_b32 v21, 0xffff0000, v177
v_mul_f32 v20, v20, v16
v_mul_f32 v21, v21, v16
v_cvt_pk_bf16_f32 v177, v20, v21
v_lshlrev_b32 v20, 16, v178
v_and_b32 v21, 0xffff0000, v178
v_mul_f32 v20, v20, v16
v_mul_f32 v21, v21, v16
v_cvt_pk_bf16_f32 v178, v20, v21
v_lshlrev_b32 v20, 16, v179
v_and_b32 v21, 0xffff0000, v179
v_mul_f32 v20, v20, v16
v_mul_f32 v21, v21, v16
v_cvt_pk_bf16_f32 v179, v20, v21
v_lshlrev_b32 v20, 16, v180
v_and_b32 v21, 0xffff0000, v180
v_mul_f32 v20, v20, v17
v_mul_f32 v21, v21, v17
v_cvt_pk_bf16_f32 v180, v20, v21
v_lshlrev_b32 v20, 16, v181
v_and_b32 v21, 0xffff0000, v181
v_mul_f32 v20, v20, v17
v_mul_f32 v21, v21, v17
v_cvt_pk_bf16_f32 v181, v20, v21
v_lshlrev_b32 v20, 16, v182
v_and_b32 v21, 0xffff0000, v182
v_mul_f32 v20, v20, v17
v_mul_f32 v21, v21, v17
v_cvt_pk_bf16_f32 v182, v20, v21
v_lshlrev_b32 v20, 16, v183
v_and_b32 v21, 0xffff0000, v183
v_mul_f32 v20, v20, v17
v_mul_f32 v21, v21, v17
v_cvt_pk_bf16_f32 v183, v20, v21
v_lshlrev_b32 v20, 16, v184
v_and_b32 v21, 0xffff0000, v184
v_mul_f32 v20, v20, v16
v_mul_f32 v21, v21, v16
v_cvt_pk_bf16_f32 v184, v20, v21
v_lshlrev_b32 v20, 16, v185
v_and_b32 v21, 0xffff0000, v185
v_mul_f32 v20, v20, v16
v_mul_f32 v21, v21, v16
v_cvt_pk_bf16_f32 v185, v20, v21
v_lshlrev_b32 v20, 16, v186
v_and_b32 v21, 0xffff0000, v186
v_mul_f32 v20, v20, v16
v_mul_f32 v21, v21, v16
v_cvt_pk_bf16_f32 v186, v20, v21
v_lshlrev_b32 v20, 16, v187
v_and_b32 v21, 0xffff0000, v187
v_mul_f32 v20, v20, v16
v_mul_f32 v21, v21, v16
v_cvt_pk_bf16_f32 v187, v20, v21
v_lshlrev_b32 v20, 16, v188
v_and_b32 v21, 0xffff0000, v188
v_mul_f32 v20, v20, v17
v_mul_f32 v21, v21, v17
v_cvt_pk_bf16_f32 v188, v20, v21
v_lshlrev_b32 v20, 16, v189
v_and_b32 v21, 0xffff0000, v189
v_mul_f32 v20, v20, v17
v_mul_f32 v21, v21, v17
v_cvt_pk_bf16_f32 v189, v20, v21
v_lshlrev_b32 v20, 16, v190
v_and_b32 v21, 0xffff0000, v190
v_mul_f32 v20, v20, v17
v_mul_f32 v21, v21, v17
v_cvt_pk_bf16_f32 v190, v20, v21
v_lshlrev_b32 v20, 16, v191
v_and_b32 v21, 0xffff0000, v191
v_mul_f32 v20, v20, v17
v_mul_f32 v21, v21, v17
v_cvt_pk_bf16_f32 v191, v20, v21
v_lshlrev_b32 v20, 16, v192
v_and_b32 v21, 0xffff0000, v192
v_mul_f32 v20, v20, v16
v_mul_f32 v21, v21, v16
v_cvt_pk_bf16_f32 v192, v20, v21
v_lshlrev_b32 v20, 16, v193
v_and_b32 v21, 0xffff0000, v193
v_mul_f32 v20, v20, v16
v_mul_f32 v21, v21, v16
v_cvt_pk_bf16_f32 v193, v20, v21
v_lshlrev_b32 v20, 16, v194
v_and_b32 v21, 0xffff0000, v194
v_mul_f32 v20, v20, v16
v_mul_f32 v21, v21, v16
v_cvt_pk_bf16_f32 v194, v20, v21
v_lshlrev_b32 v20, 16, v195
v_and_b32 v21, 0xffff0000, v195
v_mul_f32 v20, v20, v16
v_mul_f32 v21, v21, v16
v_cvt_pk_bf16_f32 v195, v20, v21
v_lshlrev_b32 v20, 16, v196
v_and_b32 v21, 0xffff0000, v196
v_mul_f32 v20, v20, v17
v_mul_f32 v21, v21, v17
v_cvt_pk_bf16_f32 v196, v20, v21
v_lshlrev_b32 v20, 16, v197
v_and_b32 v21, 0xffff0000, v197
v_mul_f32 v20, v20, v17
v_mul_f32 v21, v21, v17
v_cvt_pk_bf16_f32 v197, v20, v21
v_lshlrev_b32 v20, 16, v198
v_and_b32 v21, 0xffff0000, v198
v_mul_f32 v20, v20, v17
v_mul_f32 v21, v21, v17
v_cvt_pk_bf16_f32 v198, v20, v21
v_lshlrev_b32 v20, 16, v199
v_and_b32 v21, 0xffff0000, v199
v_mul_f32 v20, v20, v17
v_mul_f32 v21, v21, v17
v_cvt_pk_bf16_f32 v199, v20, v21
v_lshlrev_b32 v20, 16, v200
v_and_b32 v21, 0xffff0000, v200
v_mul_f32 v20, v20, v16
v_mul_f32 v21, v21, v16
v_cvt_pk_bf16_f32 v200, v20, v21
v_lshlrev_b32 v20, 16, v201
v_and_b32 v21, 0xffff0000, v201
v_mul_f32 v20, v20, v16
v_mul_f32 v21, v21, v16
v_cvt_pk_bf16_f32 v201, v20, v21
v_lshlrev_b32 v20, 16, v202
v_and_b32 v21, 0xffff0000, v202
v_mul_f32 v20, v20, v16
v_mul_f32 v21, v21, v16
v_cvt_pk_bf16_f32 v202, v20, v21
v_lshlrev_b32 v20, 16, v203
v_and_b32 v21, 0xffff0000, v203
v_mul_f32 v20, v20, v16
v_mul_f32 v21, v21, v16
v_cvt_pk_bf16_f32 v203, v20, v21
v_lshlrev_b32 v20, 16, v204
v_and_b32 v21, 0xffff0000, v204
v_mul_f32 v20, v20, v17
v_mul_f32 v21, v21, v17
v_cvt_pk_bf16_f32 v204, v20, v21
v_lshlrev_b32 v20, 16, v205
v_and_b32 v21, 0xffff0000, v205
v_mul_f32 v20, v20, v17
v_mul_f32 v21, v21, v17
v_cvt_pk_bf16_f32 v205, v20, v21
v_lshlrev_b32 v20, 16, v206
v_and_b32 v21, 0xffff0000, v206
v_mul_f32 v20, v20, v17
v_mul_f32 v21, v21, v17
v_cvt_pk_bf16_f32 v206, v20, v21
v_lshlrev_b32 v20, 16, v207
v_and_b32 v21, 0xffff0000, v207
v_mul_f32 v20, v20, v17
v_mul_f32 v21, v21, v17
v_cvt_pk_bf16_f32 v207, v20, v21
v_exp_f32 v16, v64
v_exp_f32 v17, v65
v_exp_f32 v18, v66
v_exp_f32 v19, v67
v_exp_f32 v20, v68
v_exp_f32 v21, v69
v_exp_f32 v22, v70
v_exp_f32 v23, v71
v_exp_f32 v24, v72
v_exp_f32 v25, v73
v_exp_f32 v26, v74
v_exp_f32 v27, v75
v_exp_f32 v28, v76
v_exp_f32 v29, v77
v_exp_f32 v30, v78
v_exp_f32 v31, v79
s_nop 0
v_add_f32 v14, v12, v16
v_add_f32 v14, v14, v17
v_add_f32 v14, v14, v18
v_add_f32 v14, v14, v19
v_add_f32 v14, v14, v20
v_add_f32 v14, v14, v21
v_add_f32 v14, v14, v22
v_add_f32 v14, v14, v23
v_add_f32 v15, v13, v24
v_add_f32 v15, v15, v25
v_add_f32 v15, v15, v26
v_add_f32 v15, v15, v27
v_add_f32 v15, v15, v28
v_add_f32 v15, v15, v29
v_add_f32 v15, v15, v30
v_add_f32 v15, v15, v31
v_cvt_pk_bf16_f32 v40, v16, v17
v_cvt_pk_bf16_f32 v41, v18, v19
v_cvt_pk_bf16_f32 v42, v20, v21
v_cvt_pk_bf16_f32 v43, v22, v23
v_cvt_pk_bf16_f32 v44, v24, v25
v_cvt_pk_bf16_f32 v45, v26, v27
v_cvt_pk_bf16_f32 v46, v28, v29
v_cvt_pk_bf16_f32 v47, v30, v31
s_nop 1
s_branch L_back_o2
.section .rodata,"a"
.p2align 6
.amdhsa_kernel standalone__gqa_softmax__near_ridge_kernel
  .amdhsa_next_free_vgpr 512
  .amdhsa_next_free_sgpr 102
  .amdhsa_accum_offset 256
  .amdhsa_group_segment_fixed_size 0
  .amdhsa_kernarg_size 48
  .amdhsa_user_sgpr_count 2
  .amdhsa_user_sgpr_kernarg_segment_ptr 1
  .amdhsa_system_sgpr_workgroup_id_x 1
.end_amdhsa_kernel
```
